```python
import torch

def _softmax(x, axis=-1):
    return torch.softmax(x, dim=axis)
def _gelu(x):
    return torch.nn.functional.gelu(x, approximate="tanh")
def _silu(x):
    return torch.nn.functional.silu(x)
def _sigmoid(x):
    return torch.sigmoid(x)
def _layernorm(x, axis=-1, eps=1e-5):
    m = x.mean(dim=axis, keepdim=True)
    v = x.var(dim=axis, keepdim=True, unbiased=False)
    return (x - m) / torch.sqrt(v + eps)
def _scatter_add(tgt, idx, src, axis=0):
    return tgt.clone().index_add_(axis, idx, src)
def _segment_sum(src, seg, n):
    out = torch.zeros((n,) + src.shape[1:], dtype=src.dtype)
    return out.index_add_(0, seg, src)
def _pad(x, pw):
    flat = tuple(v for pair in reversed(pw) for v in pair)
    return torch.nn.functional.pad(x, flat)

kernel_name = 'concat_heads__linear_attn_block__ssm_conv_s4d__prompt'

def setup_inputs():

    _w = (lambda a: (lambda t: t.to(torch.bfloat16) if t.is_floating_point() else t)(torch.as_tensor(a)))
    def _A_setup():
        B, S, D = 1, 2048, 448
        return {
            "x": _w((lambda *s: torch.randn(*s, dtype=torch.bfloat16) * 0.05)(B, S, D)),
            "wqkv": _w((lambda *s: torch.randn(*s, dtype=torch.bfloat16) * 0.8)(D, 3 * D)),
            "wo": _w((lambda *s: torch.randn(*s, dtype=torch.bfloat16) * 0.05)(D, D)),
        }
    _A_in = _A_setup()

    def _B_setup():
        Bsz, L, D, N = 1, 2048, 448, 256
        return {
            "u": _w((lambda *s: torch.randn(*s, dtype=torch.bfloat16) * 0.05)(Bsz, L, D)),
            "log_A_real": _w((lambda *s: torch.randn(*s, dtype=torch.bfloat16) * 3.2)(D, N) * 0.5),
            "A_imag": _w((lambda *s: torch.randn(*s, dtype=torch.bfloat16) * 0.05)(D, N) * 3.14),
            "C_real": _w((lambda *s: torch.randn(*s, dtype=torch.bfloat16) * 0.2)(D, N) / N ** 0.5),
            "C_imag": _w((lambda *s: torch.randn(*s, dtype=torch.bfloat16) * 0.4)(D, N) / N ** 0.5),
            "log_dt": _w((lambda *s: torch.randn(*s, dtype=torch.bfloat16) * 0.05)(D) * 0.5 - 4.0),
            "D_skip": _w((lambda *s: torch.randn(*s, dtype=torch.bfloat16) * 0.05)(D)),
        }
    _B_in = _B_setup()

    return {
        "A_x": _A_in["x"],
        "A_wqkv": _A_in["wqkv"],
        "A_wo": _A_in["wo"],
        "B_u": _B_in["u"],
        "B_log_A_real": _B_in["log_A_real"],
        "B_A_imag": _B_in["A_imag"],
        "B_C_real": _B_in["C_real"],
        "B_C_imag": _B_in["C_imag"],
        "B_log_dt": _B_in["log_dt"],
        "B_D_skip": _B_in["D_skip"],
    }

def reference(A_x, A_wqkv, A_wo, B_u, B_log_A_real, B_A_imag, B_C_real, B_C_imag, B_log_dt, B_D_skip):
    def _A_ref(x, wqkv, wo):
        B, S, D = x.shape
        H = 16; Dh = D // H
        qkv = (lambda x, *d: x.permute(*d))((x @ wqkv).reshape(B, S, 3, H, Dh), 2, 0, 3, 1, 4)
        q, k, v = qkv[0], qkv[1], qkv[2]
        phi = lambda t: torch.where(t > 0, t + 1, torch.exp(t)) + 1e-6
        pq, pk = phi(q), phi(k)
        kv = torch.einsum("bhsd,bhse->bhde", pk, v)
        z = torch.einsum("bhsd->bhd", pk)
        num = torch.einsum("bhqd,bhde->bhqe", pq, kv)
        den = torch.einsum("bhqd,bhd->bhq", pq, z)[..., None] + 1e-6
        o = num / den
        return (lambda x, *d: x.permute(*d))(o, 0, 2, 1, 3).reshape(B, S, D) @ wo

    def _B_ref(u, log_A_real, A_imag, C_real, C_imag, log_dt, D_skip):
        L = u.shape[1]
        dt = torch.exp(log_dt)
        A = -torch.exp(log_A_real) + 1j * A_imag
        C = (C_real + 1j * C_imag) * dt[:, None]
        pos = (lambda x, dt: x.to(dt))(torch.arange(L), log_dt.dtype)
        P = torch.exp((A * dt[:, None])[:, :, None] * pos[None, None, :])
        K = 2.0 * torch.einsum("dn,dnl->dl", C, P).real
        L2 = 2 * L
        u_t = (lambda x, *d: x.permute(*d))(u, 0, 2, 1)
        Kf = (lambda x, *a, **k: torch.fft.rfft(x.float(), *a, **k))(K, L2)
        Uf = (lambda x, *a, **k: torch.fft.rfft(x.float(), *a, **k))(u_t, L2)
        y = (lambda x, *a, **k: torch.fft.irfft(x, *a, **k).to(torch.bfloat16))(Uf * Kf[None, :, :], L2)[:, :, :L]
        y = (lambda x, *d: x.permute(*d))(y, 0, 2, 1)
        return y + u * D_skip[None, None, :]

    a = _A_ref(A_x, A_wqkv, A_wo)
    b = _B_ref(B_u, B_log_A_real, B_A_imag, B_C_real, B_C_imag, B_log_dt, B_D_skip)
    return torch.concatenate([a, b], axis=-1)
```

```asm
; @launch kernel=p1_kernel grid=(256,1,1) block=(1024,1,1) lds=160000
; @launch kernel=p2_kernel grid=(224,1,1) block=(512,1,1) lds=152832
.amdgcn_target "amdgcn-amd-amdhsa--gfx950"
.text
.globl p1_kernel
.type p1_kernel,@function
.p2align 8
p1_kernel:
  s_cmp_ge_u32 s2, 256
  s_cbranch_scc1 L1_end
  s_load_dwordx16 s[32:47], s[0:1], 0
  s_load_dwordx8 s[48:55], s[0:1], 64
  s_load_dwordx2 s[56:57], s[0:1], 96
  v_lshrrev_b32 v1, 6, v0
  v_and_b32 v0, 63, v0
  v_readfirstlane_b32 s3, v1
  v_mov_b32 v1, 159744
  s_cmp_eq_u32 s3, 0
  s_cbranch_scc0 L1_nz
  v_lshl_add_u32 v2, v0, 2, v1
  v_mov_b32_e64 v3, 0
  ds_write_b32 v2, v3
L1_nz:
  s_and_b32 s28, s2, 7
  s_lshr_b32 s29, s2, 3
  s_lshr_b32 s30, s28, 1
  s_and_b32 s31, s28, 1
  s_and_b32 s22, s3, 3
  s_cmp_lt_u32 s29, 23
  s_cselect_b32 s59, 1, 0
  s_waitcnt lgkmcnt(0)
  s_lshr_b32 s60, s3, 2
  s_cmp_eq_u32 s60, 1
  s_cselect_b32 s60, s59, 0
  s_cmp_eq_u32 s60, 1
  s_cbranch_scc1 L1_nobar
  s_barrier
L1_nobar:
  s_mov_b32 s12, s56
  s_mov_b32 s13, s57
  s_mov_b32 s14, 0x1000000
  s_mov_b32 s15, 0x20000
  s_cmp_ge_u32 s29, 23
  s_cbranch_scc1 L1_aux
  s_cmp_lt_u32 s29, 16
  s_cselect_b32 s60, 12, 16
  s_cmp_ge_u32 s3, s60
  s_cbranch_scc1 L1_g
  s_cmp_ge_u32 s3, 8
  s_cbranch_scc1 L1_gk
L1_g:
  s_cmp_ge_u32 s29, 16
  s_cbranch_scc1 L1_qwg
  s_lshl_b32 s20, s30, 2
  s_and_b32 s60, s29, 3
  s_add_u32 s20, s20, s60
  s_lshl_b32 s21, s31, 2
  s_lshr_b32 s60, s29, 2
  s_add_u32 s21, s21, s60
  s_lshr_b32 s60, s3, 2
  s_cmp_eq_u32 s60, 1
  s_cbranch_scc0 L1_kv_g0
  s_setprio 3
  s_mov_b32 s4, s32
  s_mov_b32 s5, s33
  s_mov_b32 s6, 0x1c0000
  s_mov_b32 s7, 0x20000
  s_mov_b32 s8, s34
  s_mov_b32 s9, s35
  s_mov_b32 s10, 0x126000
  s_mov_b32 s11, 0x20000
  v_lshrrev_b32 v2, 3, v0
  v_and_b32 v3, 7, v0
  v_lshrrev_b32 v6, 4, v0
  v_xor_b32 v4, v3, v6
  s_lshl_b32 s60, s20, 7
  v_add_u32 v5, s60, v2
  v_mul_u32_u24 v5, 896, v5
  v_lshl_add_u32 v7, v4, 4, v5
  v_xor_b32_e64 v4, 4, v4
  v_lshl_add_u32 v8, v4, 4, v5
  v_add_u32 v8, 6144, v8
  v_and_b32 v5, 1, v6
  v_lshlrev_b32 v5, 2, v5
  v_xor_b32 v5, v5, v3
  v_min_u32 v5, 6, v5
  v_mul_u32_u24 v4, 2688, v2
  v_lshl_add_u32 v4, v5, 4, v4
  s_mul_i32 s61, s21, 112
  s_add_u32 s61, s61, 896
  v_add_u32 v9, s61, v4
  s_and_b32 s60, s2, 6
  s_mul_i32 s61, s31, 3
  s_add_u32 s60, s60, s61
  s_cmp_ge_u32 s60, 7
  s_cselect_b32 s61, 7, 0
  s_sub_u32 s29, s60, s61
  s_cmp_eq_u32 s22, 3
  s_cselect_b32 s27, 0, s22
  s_cselect_b32 s30, 1, 0
  v_mov_b32 v3, 1
  s_mov_b32 s25, 1
  s_cmp_eq_u32 s27, 0
  s_cbranch_scc1 L1_kv_l
  s_cmp_eq_u32 s25, 0
  s_cbranch_scc1 L1_kv_l_b0
  s_barrier
  s_mov_b32 s25, 0
L1_kv_l_b0:
L1_kv_l:
  s_add_u32 s24, s29, s27
  s_cmp_ge_u32 s24, 7
  s_cselect_b32 s61, 7, 0
  s_sub_u32 s24, s24, s61
  s_add_u32 s26, s27, 1
  s_and_b32 s26, s26, 3
  s_mul_i32 s26, s26, 32768
  s_add_u32 s26, s26, 28672
  s_lshl_b32 s60, s27, 2
  v_add_u32 v10, s60, v1
  s_cmp_lt_u32 s27, 4
  s_cbranch_scc1 L1_kv_l_nf
  s_mov_b32 s69, 0
Lpoll1:
  ds_read_b32 v2, v10 offset:16
  s_add_u32 s69, s69, 1
  s_cmp_gt_u32 s69, 0x100000
  s_cbranch_scc1 Lpoll1_x
  s_waitcnt lgkmcnt(0)
  v_readfirstlane_b32 s68, v2
  s_cmp_ge_u32 s68, 8
  s_cbranch_scc1 Lpoll1_x
  s_sleep 1
  s_branch Lpoll1
Lpoll1_x:
  s_waitcnt lgkmcnt(0)
L1_kv_l_nf:
  s_cmp_eq_u32 s27, 0
  s_cbranch_scc1 L1_kv_l_nt
  s_mov_b32 s69, 0
Lpoll2:
  ds_read_b32 v2, v10 offset:60
  s_add_u32 s69, s69, 1
  s_cmp_gt_u32 s69, 0x100000
  s_cbranch_scc1 Lpoll2_x
  s_waitcnt lgkmcnt(0)
  v_readfirstlane_b32 s68, v2
  s_cmp_ge_u32 s68, 1
  s_cbranch_scc1 Lpoll2_x
  s_sleep 1
  s_branch Lpoll2
Lpoll2_x:
  s_waitcnt lgkmcnt(0)
L1_kv_l_nt:
  s_lshl_b32 s60, s24, 7
  s_mul_i32 s61, s24, 172032
  s_cmp_eq_u32 s30, 1
  s_cbranch_scc0 L1_kv_l_h0
  s_add_u32 s60, s60, 57344
  s_add_u32 s61, s61, 86016
  s_branch L1_kv_l_h1
L1_kv_l_h0:
  s_add_u32 m0, s26, 16384
  s_nop 0
  buffer_load_dwordx4 v9, s[8:11], s61 offen lds
  s_add_u32 m0, s26, 0
  s_nop 0
  s_nop 0
  buffer_load_dwordx4 v7, s[4:7], s60 offen lds
  buffer_load_dwordx4 v8, s[4:7], s60 offen offset:1024 lds
  s_add_u32 s60, s60, 14336
  s_add_u32 m0, s26, 23680
  s_nop 0
  buffer_load_dwordx4 v9, s[8:11], s61 offen offset:896 lds
  s_add_u32 s61, s61, 21504
  s_add_u32 m0, s26, 17408
  s_nop 0
  buffer_load_dwordx4 v9, s[8:11], s61 offen lds
  s_add_u32 m0, s26, 2048
  s_nop 0
  s_nop 0
  buffer_load_dwordx4 v7, s[4:7], s60 offen lds
  buffer_load_dwordx4 v8, s[4:7], s60 offen offset:1024 lds
  s_add_u32 s60, s60, 14336
  s_add_u32 m0, s26, 24704
  s_nop 0
  buffer_load_dwordx4 v9, s[8:11], s61 offen offset:896 lds
  s_add_u32 s61, s61, 21504
  s_add_u32 m0, s26, 18432
  s_nop 0
  buffer_load_dwordx4 v9, s[8:11], s61 offen lds
  s_add_u32 m0, s26, 4096
  s_nop 0
  s_nop 0
  buffer_load_dwordx4 v7, s[4:7], s60 offen lds
  buffer_load_dwordx4 v8, s[4:7], s60 offen offset:1024 lds
  s_add_u32 s60, s60, 14336
  s_add_u32 m0, s26, 25728
  s_nop 0
  buffer_load_dwordx4 v9, s[8:11], s61 offen offset:896 lds
  s_add_u32 s61, s61, 21504
  s_add_u32 m0, s26, 19456
  s_nop 0
  buffer_load_dwordx4 v9, s[8:11], s61 offen lds
  s_add_u32 m0, s26, 6144
  s_nop 0
  s_nop 0
  buffer_load_dwordx4 v7, s[4:7], s60 offen lds
  buffer_load_dwordx4 v8, s[4:7], s60 offen offset:1024 lds
  s_add_u32 s60, s60, 14336
  s_add_u32 m0, s26, 26752
  s_nop 0
  buffer_load_dwordx4 v9, s[8:11], s61 offen offset:896 lds
  s_add_u32 s61, s61, 21504
  s_cmp_eq_u32 s25, 0
  s_cbranch_scc1 L1_kv_l_b1
  s_barrier
  s_mov_b32 s25, 0
L1_kv_l_b1:
  s_mov_b64 exec, 1
  ds_add_u32 v10, v3 offset:64
  s_mov_b64 exec, -1
  s_cmp_eq_u32 s27, 0
  s_cbranch_scc1 L1_kv_l_iss
L1_kv_l_h1:
  s_add_u32 m0, s26, 20480
  s_nop 0
  buffer_load_dwordx4 v9, s[8:11], s61 offen lds
  s_add_u32 m0, s26, 8192
  s_nop 0
  s_nop 0
  buffer_load_dwordx4 v7, s[4:7], s60 offen lds
  buffer_load_dwordx4 v8, s[4:7], s60 offen offset:1024 lds
  s_add_u32 s60, s60, 14336
  s_add_u32 m0, s26, 27776
  s_nop 0
  buffer_load_dwordx4 v9, s[8:11], s61 offen offset:896 lds
  s_add_u32 s61, s61, 21504
  s_add_u32 m0, s26, 21504
  s_nop 0
  buffer_load_dwordx4 v9, s[8:11], s61 offen lds
  s_add_u32 m0, s26, 10240
  s_nop 0
  s_nop 0
  buffer_load_dwordx4 v7, s[4:7], s60 offen lds
  buffer_load_dwordx4 v8, s[4:7], s60 offen offset:1024 lds
  s_add_u32 s60, s60, 14336
  s_add_u32 m0, s26, 28800
  s_nop 0
  buffer_load_dwordx4 v9, s[8:11], s61 offen offset:896 lds
  s_add_u32 s61, s61, 21504
  s_add_u32 m0, s26, 22528
  s_nop 0
  buffer_load_dwordx4 v9, s[8:11], s61 offen lds
  s_add_u32 m0, s26, 12288
  s_nop 0
  s_nop 0
  buffer_load_dwordx4 v7, s[4:7], s60 offen lds
  buffer_load_dwordx4 v8, s[4:7], s60 offen offset:1024 lds
  s_add_u32 s60, s60, 14336
  s_add_u32 m0, s26, 29824
  s_nop 0
  buffer_load_dwordx4 v9, s[8:11], s61 offen offset:896 lds
  s_add_u32 s61, s61, 21504
  s_add_u32 m0, s26, 23552
  s_nop 0
  buffer_load_dwordx4 v9, s[8:11], s61 offen lds
  s_add_u32 m0, s26, 14336
  s_nop 0
  s_nop 0
  buffer_load_dwordx4 v7, s[4:7], s60 offen lds
  buffer_load_dwordx4 v8, s[4:7], s60 offen offset:1024 lds
  s_add_u32 s60, s60, 14336
  s_add_u32 m0, s26, 30848
  s_nop 0
  buffer_load_dwordx4 v9, s[8:11], s61 offen offset:896 lds
  s_add_u32 s61, s61, 21504
L1_kv_l_iss:
  s_cmp_eq_u32 s25, 0
  s_cbranch_scc1 L1_kv_l_b2
  s_barrier
  s_mov_b32 s25, 0
L1_kv_l_b2:
  s_waitcnt vmcnt(0)
  s_mov_b64 exec, 1
  ds_add_u32 v10, v3 offset:0
  s_mov_b64 exec, -1
  s_cmp_eq_u32 s30, 1
  s_cselect_b32 s60, 3, 4
  s_mov_b32 s30, 0
  s_add_u32 s27, s27, s60
  s_cmp_lt_u32 s27, 7
  s_cbranch_scc1 L1_kv_l
  s_endpgm
L1_qwg:
  s_sub_u32 s60, s29, 16
  s_sub_u32 s61, 4, s31
  s_cmp_ge_u32 s60, s61
  s_cselect_b32 s62, 1, 0
  s_lshl_b32 s20, s30, 1
  s_add_u32 s20, s20, s62
  s_sub_u32 s61, s31, s62
  s_lshl_b32 s61, s61, 2
  s_add_u32 s21, s60, s61
  s_cmp_ge_u32 s3, 4
  s_cbranch_scc0 L1_q_g0
  s_setprio 3
  s_mov_b32 s4, s32
  s_mov_b32 s5, s33
  s_mov_b32 s6, 0x1c0000
  s_mov_b32 s7, 0x20000
  s_mov_b32 s8, s34
  s_mov_b32 s9, s35
  s_mov_b32 s10, 0x126000
  s_mov_b32 s11, 0x20000
  v_lshrrev_b32 v2, 3, v0
  v_and_b32 v3, 7, v0
  v_lshrrev_b32 v6, 4, v0
  v_xor_b32 v4, v3, v6
  s_lshl_b32 s60, s20, 8
  v_add_u32_e64 v5, s60, v2
  v_mul_u32_u24 v5, 896, v5
  v_lshl_add_u32 v7, v4, 4, v5
  v_xor_b32_e64 v4, 4, v4
  v_lshl_add_u32 v8, v4, 4, v5
  v_add_u32 v8, 6144, v8
  v_and_b32 v5, 1, v6
  v_lshlrev_b32 v5, 2, v5
  v_xor_b32_e64 v5, v5, v3
  v_mul_u32_u24 v4, 2688, v2
  v_lshl_add_u32 v4, v5, 4, v4
  s_lshl_b32 s61, s21, 7
  v_add_u32 v9, s61, v4
  s_and_b32 s60, s2, 6
  s_mul_i32 s61, s31, 3
  s_add_u32 s60, s60, s61
  s_cmp_ge_u32 s60, 7
  s_cselect_b32 s61, 7, 0
  s_sub_u32 s29, s60, s61
  s_cmp_eq_u32 s22, 3
  s_cselect_b32 s27, 0, s22
  s_cselect_b32 s30, 1, 0
  v_mov_b32 v3, 1
  s_mov_b32 s25, 1
  s_cmp_eq_u32 s27, 0
  s_cbranch_scc1 L1_q_l
  s_cmp_eq_u32 s25, 0
  s_cbranch_scc1 L1_q_l_b0
  s_barrier
  s_mov_b32 s25, 0
L1_q_l_b0:
L1_q_l:
  s_add_u32 s24, s29, s27
  s_cmp_ge_u32 s24, 7
  s_cselect_b32 s61, 7, 0
  s_sub_u32 s24, s24, s61
  s_mul_i32 s60, s27, 11
  s_lshr_b32 s60, s60, 5
  s_mul_i32 s60, s60, 3
  s_sub_u32 s26, s27, s60
  s_mul_i32 s26, s26, 40960
  s_add_u32 s26, s26, 36864
  s_lshl_b32 s60, s27, 2
  v_add_u32 v10, s60, v1
  s_cmp_lt_u32 s27, 3
  s_cbranch_scc1 L1_q_l_nf
  s_mov_b32 s69, 0
Lpoll3:
  ds_read_b32 v2, v10 offset:20
  s_add_u32 s69, s69, 1
  s_cmp_gt_u32 s69, 0x100000
  s_cbranch_scc1 Lpoll3_x
  s_waitcnt lgkmcnt(0)
  v_readfirstlane_b32 s68, v2
  s_cmp_ge_u32 s68, 4
  s_cbranch_scc1 Lpoll3_x
  s_sleep 1
  s_branch Lpoll3
Lpoll3_x:
  s_waitcnt lgkmcnt(0)
L1_q_l_nf:
  s_cmp_eq_u32 s27, 0
  s_cbranch_scc1 L1_q_l_nt
  s_mov_b32 s69, 0
Lpoll4:
  ds_read_b32 v2, v10 offset:60
  s_add_u32 s69, s69, 1
  s_cmp_gt_u32 s69, 0x100000
  s_cbranch_scc1 Lpoll4_x
  s_waitcnt lgkmcnt(0)
  v_readfirstlane_b32 s68, v2
  s_cmp_ge_u32 s68, 1
  s_cbranch_scc1 Lpoll4_x
  s_sleep 1
  s_branch Lpoll4
Lpoll4_x:
  s_waitcnt lgkmcnt(0)
L1_q_l_nt:
  s_lshl_b32 s60, s24, 7
  s_mul_i32 s61, s24, 172032
  s_cmp_eq_u32 s30, 1
  s_cbranch_scc0 L1_q_l_h0
  s_add_u32 s60, s60, 114688
  s_add_u32 s61, s61, 86016
  s_branch L1_q_l_h1
L1_q_l_h0:
  s_add_u32 m0, s26, 32768
  s_nop 0
  buffer_load_dwordx4 v9, s[8:11], s61 offen lds
  s_add_u32 m0, s26, 0
  s_nop 0
  buffer_load_dwordx4 v7, s[4:7], s60 offen lds
  buffer_load_dwordx4 v8, s[4:7], s60 offen offset:1024 lds
  s_add_u32 s60, s60, 14336
  s_add_u32 m0, s26, 2048
  s_nop 0
  s_nop 0
  buffer_load_dwordx4 v7, s[4:7], s60 offen lds
  buffer_load_dwordx4 v8, s[4:7], s60 offen offset:1024 lds
  s_add_u32 s60, s60, 14336
  s_add_u32 s61, s61, 21504
  s_add_u32 m0, s26, 33792
  s_nop 0
  buffer_load_dwordx4 v9, s[8:11], s61 offen lds
  s_add_u32 m0, s26, 4096
  s_nop 0
  buffer_load_dwordx4 v7, s[4:7], s60 offen lds
  buffer_load_dwordx4 v8, s[4:7], s60 offen offset:1024 lds
  s_add_u32 s60, s60, 14336
  s_add_u32 m0, s26, 6144
  s_nop 0
  s_nop 0
  buffer_load_dwordx4 v7, s[4:7], s60 offen lds
  buffer_load_dwordx4 v8, s[4:7], s60 offen offset:1024 lds
  s_add_u32 s60, s60, 14336
  s_add_u32 s61, s61, 21504
  s_add_u32 m0, s26, 34816
  s_nop 0
  buffer_load_dwordx4 v9, s[8:11], s61 offen lds
  s_add_u32 m0, s26, 8192
  s_nop 0
  buffer_load_dwordx4 v7, s[4:7], s60 offen lds
  buffer_load_dwordx4 v8, s[4:7], s60 offen offset:1024 lds
  s_add_u32 s60, s60, 14336
  s_add_u32 m0, s26, 10240
  s_nop 0
  s_nop 0
  buffer_load_dwordx4 v7, s[4:7], s60 offen lds
  buffer_load_dwordx4 v8, s[4:7], s60 offen offset:1024 lds
  s_add_u32 s60, s60, 14336
  s_add_u32 s61, s61, 21504
  s_add_u32 m0, s26, 35840
  s_nop 0
  buffer_load_dwordx4 v9, s[8:11], s61 offen lds
  s_add_u32 m0, s26, 12288
  s_nop 0
  buffer_load_dwordx4 v7, s[4:7], s60 offen lds
  buffer_load_dwordx4 v8, s[4:7], s60 offen offset:1024 lds
  s_add_u32 s60, s60, 14336
  s_add_u32 m0, s26, 14336
  s_nop 0
  s_nop 0
  buffer_load_dwordx4 v7, s[4:7], s60 offen lds
  buffer_load_dwordx4 v8, s[4:7], s60 offen offset:1024 lds
  s_add_u32 s60, s60, 14336
  s_add_u32 s61, s61, 21504
  s_cmp_eq_u32 s25, 0
  s_cbranch_scc1 L1_q_l_b1
  s_barrier
  s_mov_b32 s25, 0
L1_q_l_b1:
  s_mov_b64 exec, 1
  ds_add_u32 v10, v3 offset:64
  s_mov_b64 exec, -1
  s_cmp_eq_u32 s27, 0
  s_cbranch_scc1 L1_q_l_iss
L1_q_l_h1:
  s_add_u32 m0, s26, 36864
  s_nop 0
  buffer_load_dwordx4 v9, s[8:11], s61 offen lds
  s_add_u32 m0, s26, 16384
  s_nop 0
  buffer_load_dwordx4 v7, s[4:7], s60 offen lds
  buffer_load_dwordx4 v8, s[4:7], s60 offen offset:1024 lds
  s_add_u32 s60, s60, 14336
  s_add_u32 m0, s26, 18432
  s_nop 0
  s_nop 0
  buffer_load_dwordx4 v7, s[4:7], s60 offen lds
  buffer_load_dwordx4 v8, s[4:7], s60 offen offset:1024 lds
  s_add_u32 s60, s60, 14336
  s_add_u32 s61, s61, 21504
  s_add_u32 m0, s26, 37888
  s_nop 0
  buffer_load_dwordx4 v9, s[8:11], s61 offen lds
  s_add_u32 m0, s26, 20480
  s_nop 0
  buffer_load_dwordx4 v7, s[4:7], s60 offen lds
  buffer_load_dwordx4 v8, s[4:7], s60 offen offset:1024 lds
  s_add_u32 s60, s60, 14336
  s_add_u32 m0, s26, 22528
  s_nop 0
  s_nop 0
  buffer_load_dwordx4 v7, s[4:7], s60 offen lds
  buffer_load_dwordx4 v8, s[4:7], s60 offen offset:1024 lds
  s_add_u32 s60, s60, 14336
  s_add_u32 s61, s61, 21504
  s_add_u32 m0, s26, 38912
  s_nop 0
  buffer_load_dwordx4 v9, s[8:11], s61 offen lds
  s_add_u32 m0, s26, 24576
  s_nop 0
  buffer_load_dwordx4 v7, s[4:7], s60 offen lds
  buffer_load_dwordx4 v8, s[4:7], s60 offen offset:1024 lds
  s_add_u32 s60, s60, 14336
  s_add_u32 m0, s26, 26624
  s_nop 0
  s_nop 0
  buffer_load_dwordx4 v7, s[4:7], s60 offen lds
  buffer_load_dwordx4 v8, s[4:7], s60 offen offset:1024 lds
  s_add_u32 s60, s60, 14336
  s_add_u32 s61, s61, 21504
  s_add_u32 m0, s26, 39936
  s_nop 0
  buffer_load_dwordx4 v9, s[8:11], s61 offen lds
  s_add_u32 m0, s26, 28672
  s_nop 0
  buffer_load_dwordx4 v7, s[4:7], s60 offen lds
  buffer_load_dwordx4 v8, s[4:7], s60 offen offset:1024 lds
  s_add_u32 s60, s60, 14336
  s_add_u32 m0, s26, 30720
  s_nop 0
  s_nop 0
  buffer_load_dwordx4 v7, s[4:7], s60 offen lds
  buffer_load_dwordx4 v8, s[4:7], s60 offen offset:1024 lds
  s_add_u32 s60, s60, 14336
  s_add_u32 s61, s61, 21504
L1_q_l_iss:
  s_cmp_eq_u32 s25, 0
  s_cbranch_scc1 L1_q_l_b2
  s_barrier
  s_mov_b32 s25, 0
L1_q_l_b2:
  s_waitcnt vmcnt(0)
  s_mov_b64 exec, 1
  ds_add_u32 v10, v3 offset:0
  s_mov_b64 exec, -1
  s_cmp_eq_u32 s30, 1
  s_cselect_b32 s60, 3, 4
  s_mov_b32 s30, 0
  s_add_u32 s27, s27, s60
  s_cmp_lt_u32 s27, 7
  s_cbranch_scc1 L1_q_l
  s_endpgm
L1_kv_g0:
  s_mov_b32 s16, s54
  s_mov_b32 s17, s55
  s_mov_b32 s18, 0x100
  s_mov_b32 s19, 0x20000
  s_lshr_b32 s23, s3, 3
  s_lshl_b32 s24, s21, 1
  s_add_u32 s24, s24, s23
  s_cmp_eq_u32 s22, 0
  s_cbranch_scc0 L1_kv_g_tk
  s_cmp_eq_u32 s20, s24
  s_cbranch_scc0 L1_kv_g_tk
  s_lshl_b32 s60, s24, 12
  s_add_u32 s60, s60, 0x620000
  v_lshlrev_b32 v6, 4, v0
  v_mov_b32 v12, 0
  v_mov_b32 v13, 0
  v_mov_b32 v14, 0
  v_mov_b32_e64 v15, 0
  buffer_store_dwordx4 v[12:15], v6, s[12:15], s60 offen offset:0 sc0 sc1
  buffer_store_dwordx4 v[12:15], v6, s[12:15], s60 offen offset:1024 sc0 sc1
  buffer_store_dwordx4 v[12:15], v6, s[12:15], s60 offen offset:2048 sc0 sc1
  buffer_store_dwordx4 v[12:15], v6, s[12:15], s60 offen offset:3072 sc0 sc1
  s_lshl_b32 s60, s24, 2
  v_mov_b32 v4, s60
  v_mov_b32 v5, 1
  s_waitcnt vmcnt(0)
  s_mov_b64 exec, 1
  buffer_store_dword v5, v4, s[16:19], 0 offen offset:64 sc0 sc1
  s_mov_b64 exec, -1
L1_kv_g_tk:
  v_mov_b32 v2, v1
  v_mov_b32 v19, 1
  v_and_b32 v4, 31, v0
  v_lshrrev_b32 v18, 5, v0
  s_lshl_b32 s60, s22, 12
  s_add_u32 s60, s60, 61440
  v_bfe_u32 v6, v0, 1, 3
  v_xor_b32 v6, v6, v18
  v_lshlrev_b32_e64 v6, 4, v6
  v_lshl_add_u32 v6, v4, 7, v6
  v_add_u32 v12, s60, v6
  v_xor_b32 v13, 32, v12
  v_xor_b32_e64 v14, 64, v12
  v_xor_b32 v15, 96, v12
  v_bfe_u32 v6, v0, 2, 2
  v_lshl_add_u32 v7, v18, 3, v6
  v_and_b32 v8, 3, v0
  v_lshlrev_b32 v8, 3, v8
  v_bfe_u32 v9, v0, 4, 1
  v_lshl_add_u32 v8, v9, 5, v8
  s_mul_i32 s60, s23, 56
  v_add_u32 v8, s60, v8
  v_lshrrev_b32 v6, 1, v6
  v_lshlrev_b32 v6, 6, v6
  v_xor_b32_e64 v8, v8, v6
  v_lshl_add_u32 v8, v7, 7, v8
  v_add_u32 v16, 77824, v8
  v_mov_b32 v9, 0x358637bd
  v_mov_b32 v20, v9
  v_mov_b32 v21, v9
  v_mov_b32 v22, v9
  v_mov_b32 v23, v9
  v_mov_b32 v24, v9
  v_mov_b32 v25, v9
  v_mov_b32 v26, v9
  v_mov_b32 v27, v9
  v_mov_b32 v28, v9
  v_mov_b32 v29, v9
  v_mov_b32 v30, v9
  v_mov_b32 v31, v9
  v_mov_b32 v32, v9
  v_mov_b32 v33, v9
  v_mov_b32 v34, v9
  v_mov_b32 v35, v9
  v_mov_b32 v36, 0
  v_mov_b32 v37, 0
  v_mov_b32 v38, 0
  v_mov_b32 v39, 0
  v_mov_b32 v40, 0
  v_mov_b32 v41, 0
  v_mov_b32 v42, 0
  v_mov_b32 v43, 0
  v_mov_b32 v44, 0
  v_mov_b32 v45, 0
  v_mov_b32 v46, 0
  v_mov_b32 v47, 0
  v_mov_b32 v48, 0
  v_mov_b32 v49, 0
  v_mov_b32 v50, 0
  v_mov_b32 v51, 0
  v_mov_b32 v52, 0x3fb8aa3b
  v_mov_b32 v53, 0x3fb8aa3b
  v_mov_b32 v54, 0xb5c1a2a0
  v_mov_b32 v55, 0xb5c1a2a0
  v_lshlrev_b32 v6, 4, v0
  s_lshl_b32 s60, s23, 14
  s_add_u32 s60, s60, 61440
  v_add_u32 v6, s60, v6
  s_lshl_b32 s60, s22, 10
  v_add_u32 v57, s60, v6
  s_lshl_b32 s60, s22, 12
  v_add_u32 v58, s60, v6
  s_lshl_b32 s60, s23, 2
  v_add_u32_e64 v59, s60, v1
  v_cmp_eq_u32 s[32:33], 28, v4
  v_mul_u32_u24 v8, 37, v4
  v_lshrrev_b32 v8, 8, v8
  v_mul_u32_u24 v9, 7, v8
  v_sub_u32 v9, v4, v9
  v_lshlrev_b32 v8, 4, v8
  v_and_b32 v56, 3, v9
  v_lshl_add_u32 v8, v56, 2, v8
  v_lshrrev_b32_e64 v9, 2, v9
  v_lshl_add_u32 v8, v9, 11, v8
  v_mov_b32 v9, 2060
  v_cndmask_b32 v8, v8, v9, s[32:33]
  v_lshl_add_u32 v8, v18, 10, v8
  s_lshl_b32 s60, s24, 12
  s_lshl_b32 s61, s22, 6
  s_add_u32 s60, s60, s61
  s_add_u32 s60, s60, 0x620000
  v_add_u32 v8, s60, v8
  v_mov_b32 v9, 0x7ff00000
  v_cmp_gt_u32 s[60:61], 29, v4
  s_cmp_eq_u32 s22, 3
  s_cselect_b32 s61, 0, s61
  v_cndmask_b32 v56, v9, v8, s[60:61]
  s_lshl_b32 s60, s24, 2
  s_add_u32 s60, s60, 64
  v_mov_b32 v61, s60
  s_mov_b32 s27, 0
  s_mov_b32 s28, 1
  s_mov_b32 s29, 32768
  s_setprio 2
  s_mov_b32 s69, 0
Lpoll5:
  ds_read_b32 v3, v2 offset:0
  s_add_u32 s69, s69, 1
  s_cmp_gt_u32 s69, 0x100000
  s_cbranch_scc1 Lpoll5_x
  s_waitcnt lgkmcnt(0)
  v_readfirstlane_b32 s68, v3
  s_cmp_ge_u32 s68, 2
  s_cbranch_scc1 Lpoll5_x
  s_branch Lpoll5
Lpoll5_x:
  s_waitcnt lgkmcnt(0)
  s_nop 0
  ds_read_b128 v[72:75], v12
  ds_read_b64_tr_b16 v[64:65], v16 offset:0
  ds_read_b64_tr_b16 v[66:67], v16 offset:512
  ds_read_b64_tr_b16 v[68:69], v16 offset:8192
  ds_read_b64_tr_b16 v[70:71], v16 offset:8704
  ds_read_b128 v[84:87], v13
  ds_read_b64_tr_b16 v[76:77], v16 offset:2048
  ds_read_b64_tr_b16 v[78:79], v16 offset:2560
  ds_read_b64_tr_b16 v[80:81], v16 offset:10240
  ds_read_b64_tr_b16 v[82:83], v16 offset:10752
L1_kv_g_top:
  ds_read_b128 v[96:99], v14
  ds_read_b64_tr_b16 v[88:89], v16 offset:4096
  ds_read_b64_tr_b16 v[90:91], v16 offset:4608
  ds_read_b64_tr_b16 v[92:93], v16 offset:12288
  ds_read_b64_tr_b16 v[94:95], v16 offset:12800
  s_waitcnt lgkmcnt(10)
  s_nop 0
  v_mfma_f32_32x32x16_bf16 v[20:35], v[72:75], v[64:67], v[20:35]
  ds_read_b128 v[108:111], v15
  ds_read_b64_tr_b16 v[100:101], v16 offset:6144
  ds_read_b64_tr_b16 v[102:103], v16 offset:6656
  v_mfma_f32_32x32x16_bf16 v[36:51], v[72:75], v[68:71], v[36:51]
  ds_read_b64_tr_b16 v[104:105], v16 offset:14336
  ds_read_b64_tr_b16 v[106:107], v16 offset:14848
  ds_read_b32 v3, v2 offset:4
  s_waitcnt lgkmcnt(11)
  v_mfma_f32_32x32x16_bf16 v[20:35], v[84:87], v[76:79], v[20:35]
  v_mfma_f32_32x32x16_bf16 v[36:51], v[84:87], v[80:83], v[36:51]
  s_add_u32 s27, s27, 1
  s_add_u32 s28, s28, 1
  s_cmp_eq_u32 s28, 4
  s_cselect_b32 s28, 0, s28
  s_cselect_b32 s60, -98304, s29
  v_add_u32 v12, s60, v12
  v_add_u32 v13, s60, v13
  v_add_u32 v14, s60, v14
  v_add_u32 v15, s60, v15
  v_add_u32 v16, s60, v16
  s_waitcnt lgkmcnt(6)
  v_mfma_f32_32x32x16_bf16 v[20:35], v[96:99], v[88:91], v[20:35]
  v_mfma_f32_32x32x16_bf16 v[36:51], v[96:99], v[92:95], v[36:51]
  s_waitcnt lgkmcnt(0)
  s_mov_b64 exec, 1
  ds_add_u32 v2, v19 offset:32
  s_mov_b64 exec, -1
L1_kv_g_nf:
  v_add_u32 v2, 4, v2
  v_readfirstlane_b32 s68, v3
  s_cmp_eq_u32 s27, 7
  s_cbranch_scc1 L1_kv_g_last
  s_cmp_ge_u32 s68, 1
  s_cbranch_scc0 L1_kv_g_slow
  ds_read_b128 v[72:75], v12
  ds_read_b64_tr_b16 v[64:65], v16 offset:0
  ds_read_b64_tr_b16 v[66:67], v16 offset:512
  ds_read_b64_tr_b16 v[68:69], v16 offset:8192
  ds_read_b64_tr_b16 v[70:71], v16 offset:8704
  v_mfma_f32_32x32x16_bf16 v[20:35], v[108:111], v[100:103], v[20:35]
  ds_read_b128 v[84:87], v13
  ds_read_b64_tr_b16 v[76:77], v16 offset:2048
  ds_read_b64_tr_b16 v[78:79], v16 offset:2560
  ds_read_b64_tr_b16 v[80:81], v16 offset:10240
  ds_read_b64_tr_b16 v[82:83], v16 offset:10752
  v_mfma_f32_32x32x16_bf16 v[36:51], v[108:111], v[104:107], v[36:51]
  s_branch L1_kv_g_top
L1_kv_g_slow:
  v_mfma_f32_32x32x16_bf16 v[20:35], v[108:111], v[100:103], v[20:35]
  v_mfma_f32_32x32x16_bf16 v[36:51], v[108:111], v[104:107], v[36:51]
  s_mov_b32 s69, 0
Lpoll6:
  ds_read_b32 v3, v2 offset:0
  s_add_u32 s69, s69, 1
  s_cmp_gt_u32 s69, 0x100000
  s_cbranch_scc1 Lpoll6_x
  s_waitcnt lgkmcnt(0)
  v_readfirstlane_b32 s68, v3
  s_cmp_ge_u32 s68, 1
  s_cbranch_scc1 Lpoll6_x
  s_branch Lpoll6
Lpoll6_x:
  s_waitcnt lgkmcnt(0)
  ds_read_b128 v[72:75], v12
  ds_read_b64_tr_b16 v[64:65], v16 offset:0
  ds_read_b64_tr_b16 v[66:67], v16 offset:512
  ds_read_b64_tr_b16 v[68:69], v16 offset:8192
  ds_read_b64_tr_b16 v[70:71], v16 offset:8704
  ds_read_b128 v[84:87], v13
  ds_read_b64_tr_b16 v[76:77], v16 offset:2048
  ds_read_b64_tr_b16 v[78:79], v16 offset:2560
  ds_read_b64_tr_b16 v[80:81], v16 offset:10240
  ds_read_b64_tr_b16 v[82:83], v16 offset:10752
  s_branch L1_kv_g_top
L1_kv_g_last:
  s_mov_b64 exec, 1
  buffer_load_dword v60, v61, s[16:19], 0 offen sc0 sc1
  s_mov_b64 exec, -1
  v_mfma_f32_32x32x16_bf16 v[20:35], v[108:111], v[100:103], v[20:35]
  v_mfma_f32_32x32x16_bf16 v[36:51], v[108:111], v[104:107], v[36:51]
  s_setprio 0
  v_mov_b32 v2, 0x358637bd
  v_mov_b32 v5, 0x3f803f80
  ds_read_b32 v3, v1 offset:48
  s_nop 6
  s_nop 0
  v_pk_fma_f32 v[62:63], v[20:21], v[52:53], v[54:55]
  v_pk_fma_f32 v[64:65], v[22:23], v[52:53], v[54:55]
  v_pk_fma_f32 v[66:67], v[24:25], v[52:53], v[54:55]
  v_pk_fma_f32 v[68:69], v[26:27], v[52:53], v[54:55]
  v_exp_f32_e64 v62, v62 clamp
  v_max_f32_e64 v20, v2, v20
  v_exp_f32_e64 v63, v63 clamp
  v_max_f32_e64 v21, v2, v21
  v_exp_f32_e64 v64, v64 clamp
  v_max_f32_e64 v22, v2, v22
  v_exp_f32_e64 v65, v65 clamp
  v_max_f32_e64 v23, v2, v23
  v_exp_f32_e64 v66, v66 clamp
  v_max_f32_e64 v24, v2, v24
  v_exp_f32_e64 v67, v67 clamp
  v_max_f32_e64 v25, v2, v25
  v_exp_f32_e64 v68, v68 clamp
  v_max_f32_e64 v26, v2, v26
  v_exp_f32_e64 v69, v69 clamp
  v_max_f32_e64 v27, v2, v27
  v_pk_add_f32 v[20:21], v[20:21], v[62:63]
  v_pk_add_f32 v[22:23], v[22:23], v[64:65]
  v_pk_add_f32 v[24:25], v[24:25], v[66:67]
  v_pk_add_f32 v[26:27], v[26:27], v[68:69]
  v_cvt_pk_bf16_f32 v72, v20, v21
  v_cvt_pk_bf16_f32 v73, v22, v23
  v_cvt_pk_bf16_f32 v74, v24, v25
  v_cvt_pk_bf16_f32 v75, v26, v27
  v_pk_fma_f32 v[62:63], v[28:29], v[52:53], v[54:55]
  v_pk_fma_f32 v[64:65], v[30:31], v[52:53], v[54:55]
  v_pk_fma_f32 v[66:67], v[32:33], v[52:53], v[54:55]
  v_pk_fma_f32 v[68:69], v[34:35], v[52:53], v[54:55]
  v_exp_f32_e64 v62, v62 clamp
  v_max_f32_e64 v28, v2, v28
  v_exp_f32_e64 v63, v63 clamp
  v_max_f32_e64 v29, v2, v29
  v_exp_f32_e64 v64, v64 clamp
  v_max_f32_e64 v30, v2, v30
  v_exp_f32_e64 v65, v65 clamp
  v_max_f32_e64 v31, v2, v31
  v_exp_f32_e64 v66, v66 clamp
  v_max_f32_e64 v32, v2, v32
  v_exp_f32_e64 v67, v67 clamp
  v_max_f32_e64 v33, v2, v33
  v_exp_f32_e64 v68, v68 clamp
  v_max_f32_e64 v34, v2, v34
  v_exp_f32_e64 v69, v69 clamp
  v_max_f32_e64 v35, v2, v35
  v_pk_add_f32 v[28:29], v[28:29], v[62:63]
  v_pk_add_f32 v[30:31], v[30:31], v[64:65]
  v_pk_add_f32 v[32:33], v[32:33], v[66:67]
  v_pk_add_f32 v[34:35], v[34:35], v[68:69]
  v_cvt_pk_bf16_f32 v76, v28, v29
  v_cvt_pk_bf16_f32 v77, v30, v31
  v_cvt_pk_bf16_f32 v78, v32, v33
  v_cvt_pk_bf16_f32 v79, v34, v35
  v_cvt_pk_bf16_f32 v80, v36, v37
  v_cvt_pk_bf16_f32 v81, v38, v39
  v_cvt_pk_bf16_f32 v82, v40, v41
  v_cvt_pk_bf16_f32 v83, v42, v43
  v_cvt_pk_bf16_f32 v84, v44, v45
  v_cvt_pk_bf16_f32 v85, v46, v47
  v_cvt_pk_bf16_f32 v86, v48, v49
  v_cvt_pk_bf16_f32 v87, v50, v51
  v_cndmask_b32 v80, v80, v5, s[32:33]
  v_cndmask_b32 v81, v81, v5, s[32:33]
  v_cndmask_b32 v82, v82, v5, s[32:33]
  v_cndmask_b32 v83, v83, v5, s[32:33]
  v_cndmask_b32 v84, v84, v5, s[32:33]
  v_cndmask_b32 v85, v85, v5, s[32:33]
  v_cndmask_b32 v86, v86, v5, s[32:33]
  v_cndmask_b32 v87, v87, v5, s[32:33]
  v_mfma_f32_32x32x16_bf16 v[36:51], v[72:75], v[80:83], 0
  s_nop 0
  v_mfma_f32_32x32x16_bf16 v[36:51], v[76:79], v[84:87], v[36:51]
  s_waitcnt lgkmcnt(0)
  v_readfirstlane_b32 s68, v3
  s_cmp_ge_u32 s68, 8
  s_cbranch_scc1 L1_kv_g_fr
  s_mov_b32 s69, 0
Lpoll7:
  ds_read_b32 v3, v1 offset:48
  s_add_u32 s69, s69, 1
  s_cmp_gt_u32 s69, 0x100000
  s_cbranch_scc1 Lpoll7_x
  s_waitcnt lgkmcnt(0)
  v_readfirstlane_b32 s68, v3
  s_cmp_ge_u32 s68, 8
  s_cbranch_scc1 Lpoll7_x
  s_branch Lpoll7
Lpoll7_x:
  s_waitcnt lgkmcnt(0)
L1_kv_g_fr:
  s_nop 7
  s_nop 0
  ds_write_b128 v57, v[36:39] offset:0
  ds_write_b128 v57, v[40:43] offset:4096
  ds_write_b128 v57, v[44:47] offset:8192
  ds_write_b128 v57, v[48:51] offset:12288
  s_mov_b64 exec, 1
  ds_add_u32 v59, v19 offset:96
  s_mov_b64 exec, -1
  s_mov_b32 s69, 0
Lpoll8:
  ds_read_b32 v3, v59 offset:96
  s_add_u32 s69, s69, 1
  s_cmp_gt_u32 s69, 0x100000
  s_cbranch_scc1 Lpoll8_x
  s_waitcnt lgkmcnt(0)
  v_readfirstlane_b32 s68, v3
  s_cmp_ge_u32 s68, 4
  s_cbranch_scc1 Lpoll8_x
  s_branch Lpoll8
Lpoll8_x:
  s_waitcnt lgkmcnt(0)
  s_nop 0
  ds_read_b128 v[20:23], v58 offset:0
  ds_read_b128 v[24:27], v58 offset:1024
  ds_read_b128 v[28:31], v58 offset:2048
  ds_read_b128 v[32:35], v58 offset:3072
  s_mov_b32 s64, 0
L1_kv_g_poll:
  s_waitcnt vmcnt(0)
  v_readfirstlane_b32 s60, v60
  s_cmp_lg_u32 s60, 0
  s_cbranch_scc1 L1_kv_g_polled
  s_add_u32 s64, s64, 1
  s_cmp_gt_u32 s64, 0x40000
  s_cbranch_scc1 L1_kv_g_polled
  s_sleep 2
  buffer_load_dword v60, v61, s[16:19], 0 offen sc0 sc1
  s_branch L1_kv_g_poll
L1_kv_g_polled:
  s_waitcnt lgkmcnt(0)
  v_pk_add_f32 v[20:21], v[20:21], v[24:25]
  v_pk_add_f32 v[28:29], v[28:29], v[32:33]
  v_pk_add_f32 v[22:23], v[22:23], v[26:27]
  v_pk_add_f32 v[30:31], v[30:31], v[34:35]
  v_pk_add_f32 v[20:21], v[20:21], v[28:29]
  v_pk_add_f32 v[22:23], v[22:23], v[30:31]
  buffer_atomic_add_f32 v20, v56, s[12:15], 0 offen offset:0
  buffer_atomic_add_f32 v21, v56, s[12:15], 0 offen offset:256
  buffer_atomic_add_f32 v22, v56, s[12:15], 0 offen offset:512
  buffer_atomic_add_f32 v23, v56, s[12:15], 0 offen offset:768
  s_endpgm
L1_q_g0:
  v_mov_b32 v2, v1
  v_mov_b32 v19, 1
  v_and_b32 v4, 31, v0
  v_lshrrev_b32 v18, 5, v0
  s_lshl_b32 s60, s22, 13
  s_add_u32 s60, s60, 36864
  v_bfe_u32 v6, v0, 1, 3
  v_xor_b32 v6, v6, v18
  v_lshlrev_b32 v6, 4, v6
  v_lshl_add_u32 v6, v4, 7, v6
  v_add_u32 v12, s60, v6
  v_xor_b32 v13, 32, v12
  v_xor_b32_e64 v14, 64, v12
  v_xor_b32 v15, 96, v12
  v_bfe_u32 v6, v0, 2, 2
  v_lshl_add_u32 v7, v18, 3, v6
  v_and_b32 v8, 3, v0
  v_lshlrev_b32 v8, 3, v8
  v_bfe_u32 v9, v0, 4, 1
  v_lshl_add_u32 v8, v9, 5, v8
  v_lshrrev_b32 v6, 1, v6
  v_lshlrev_b32 v6, 6, v6
  v_xor_b32_e64 v8, v8, v6
  v_lshl_add_u32 v8, v7, 7, v8
  v_add_u32 v16, 69632, v8
  v_xor_b32_e64 v17, 64, v16
  v_mov_b32 v9, 0x358637bd
  v_mov_b32 v20, v9
  v_mov_b32 v21, v9
  v_mov_b32 v22, v9
  v_mov_b32 v23, v9
  v_mov_b32 v24, v9
  v_mov_b32 v25, v9
  v_mov_b32 v26, v9
  v_mov_b32 v27, v9
  v_mov_b32 v28, v9
  v_mov_b32 v29, v9
  v_mov_b32 v30, v9
  v_mov_b32 v31, v9
  v_mov_b32 v32, v9
  v_mov_b32 v33, v9
  v_mov_b32 v34, v9
  v_mov_b32 v35, v9
  v_mov_b32 v36, v9
  v_mov_b32 v37, v9
  v_mov_b32 v38, v9
  v_mov_b32 v39, v9
  v_mov_b32 v40, v9
  v_mov_b32 v41, v9
  v_mov_b32 v42, v9
  v_mov_b32 v43, v9
  v_mov_b32 v44, v9
  v_mov_b32 v45, v9
  v_mov_b32 v46, v9
  v_mov_b32 v47, v9
  v_mov_b32 v48, v9
  v_mov_b32 v49, v9
  v_mov_b32 v50, v9
  v_mov_b32 v51, v9
  v_mov_b32 v52, v9
  v_mov_b32 v53, v9
  v_mov_b32 v54, v9
  v_mov_b32 v55, v9
  v_mov_b32 v56, v9
  v_mov_b32 v57, v9
  v_mov_b32 v58, v9
  v_mov_b32 v59, v9
  v_mov_b32 v60, v9
  v_mov_b32 v61, v9
  v_mov_b32 v62, v9
  v_mov_b32 v63, v9
  v_mov_b32 v64, v9
  v_mov_b32 v65, v9
  v_mov_b32 v66, v9
  v_mov_b32 v67, v9
  v_mov_b32 v68, v9
  v_mov_b32 v69, v9
  v_mov_b32 v70, v9
  v_mov_b32 v71, v9
  v_mov_b32 v72, v9
  v_mov_b32 v73, v9
  v_mov_b32 v74, v9
  v_mov_b32 v75, v9
  v_mov_b32 v76, v9
  v_mov_b32 v77, v9
  v_mov_b32 v78, v9
  v_mov_b32 v79, v9
  v_mov_b32 v80, v9
  v_mov_b32 v81, v9
  v_mov_b32 v82, v9
  v_mov_b32 v83, v9
  v_mov_b32 v84, 0x3fb8aa3b
  v_mov_b32 v85, 0x3fb8aa3b
  v_mov_b32 v86, 0xb5c1a2a0
  v_mov_b32 v87, 0xb5c1a2a0
  s_lshl_b32 s60, s20, 4
  s_lshl_b32 s61, s22, 2
  s_add_u32 s60, s60, s61
  s_lshl_b32 s30, s60, 14
  s_lshl_b32 s60, s21, 4
  s_add_u32 s60, s60, 0
  s_mul_i32 s61, s60, 147
  s_lshr_b32 s61, s61, 10
  s_mul_i32 s62, s61, 7
  s_sub_u32 s62, s60, s62
  s_lshl_b32 s61, s61, 10
  s_lshr_b32 s63, s62, 1
  s_lshl_b32 s63, s63, 8
  s_add_u32 s61, s61, s63
  s_and_b32 s63, s62, 1
  s_cselect_b32 s64, 248, 8
  s_lshl_b32 s63, s63, 3
  s_add_u32 s61, s61, s63
  s_add_u32 s32, s61, s30
  s_cmp_eq_u32 s62, 6
  s_cselect_b32 s33, 256, s64
  s_lshl_b32 s60, s21, 4
  s_add_u32 s60, s60, 2
  s_mul_i32 s61, s60, 147
  s_lshr_b32 s61, s61, 10
  s_mul_i32 s62, s61, 7
  s_sub_u32 s62, s60, s62
  s_lshl_b32 s61, s61, 10
  s_lshr_b32 s63, s62, 1
  s_lshl_b32 s63, s63, 8
  s_add_u32 s61, s61, s63
  s_and_b32 s63, s62, 1
  s_cselect_b32 s64, 248, 8
  s_lshl_b32 s63, s63, 3
  s_add_u32 s61, s61, s63
  s_add_u32 s34, s61, s30
  s_cmp_eq_u32 s62, 6
  s_cselect_b32 s35, 256, s64
  s_lshl_b32 s60, s21, 4
  s_add_u32 s60, s60, 4
  s_mul_i32 s61, s60, 147
  s_lshr_b32 s61, s61, 10
  s_mul_i32 s62, s61, 7
  s_sub_u32 s62, s60, s62
  s_lshl_b32 s61, s61, 10
  s_lshr_b32 s63, s62, 1
  s_lshl_b32 s63, s63, 8
  s_add_u32 s61, s61, s63
  s_and_b32 s63, s62, 1
  s_cselect_b32 s64, 248, 8
  s_lshl_b32 s63, s63, 3
  s_add_u32 s61, s61, s63
  s_add_u32 s36, s61, s30
  s_cmp_eq_u32 s62, 6
  s_cselect_b32 s37, 256, s64
  s_lshl_b32 s60, s21, 4
  s_add_u32 s60, s60, 6
  s_mul_i32 s61, s60, 147
  s_lshr_b32 s61, s61, 10
  s_mul_i32 s62, s61, 7
  s_sub_u32 s62, s60, s62
  s_lshl_b32 s61, s61, 10
  s_lshr_b32 s63, s62, 1
  s_lshl_b32 s63, s63, 8
  s_add_u32 s61, s61, s63
  s_and_b32 s63, s62, 1
  s_cselect_b32 s64, 248, 8
  s_lshl_b32 s63, s63, 3
  s_add_u32 s61, s61, s63
  s_add_u32 s38, s61, s30
  s_cmp_eq_u32 s62, 6
  s_cselect_b32 s39, 256, s64
  s_lshl_b32 s60, s21, 4
  s_add_u32 s60, s60, 8
  s_mul_i32 s61, s60, 147
  s_lshr_b32 s61, s61, 10
  s_mul_i32 s62, s61, 7
  s_sub_u32 s62, s60, s62
  s_lshl_b32 s61, s61, 10
  s_lshr_b32 s63, s62, 1
  s_lshl_b32 s63, s63, 8
  s_add_u32 s61, s61, s63
  s_and_b32 s63, s62, 1
  s_cselect_b32 s64, 248, 8
  s_lshl_b32 s63, s63, 3
  s_add_u32 s61, s61, s63
  s_add_u32 s40, s61, s30
  s_cmp_eq_u32 s62, 6
  s_cselect_b32 s41, 256, s64
  s_lshl_b32 s60, s21, 4
  s_add_u32 s60, s60, 10
  s_mul_i32 s61, s60, 147
  s_lshr_b32 s61, s61, 10
  s_mul_i32 s62, s61, 7
  s_sub_u32 s62, s60, s62
  s_lshl_b32 s61, s61, 10
  s_lshr_b32 s63, s62, 1
  s_lshl_b32 s63, s63, 8
  s_add_u32 s61, s61, s63
  s_and_b32 s63, s62, 1
  s_cselect_b32 s64, 248, 8
  s_lshl_b32 s63, s63, 3
  s_add_u32 s61, s61, s63
  s_add_u32 s42, s61, s30
  s_cmp_eq_u32 s62, 6
  s_cselect_b32 s43, 256, s64
  s_lshl_b32 s60, s21, 4
  s_add_u32 s60, s60, 12
  s_mul_i32 s61, s60, 147
  s_lshr_b32 s61, s61, 10
  s_mul_i32 s62, s61, 7
  s_sub_u32 s62, s60, s62
  s_lshl_b32 s61, s61, 10
  s_lshr_b32 s63, s62, 1
  s_lshl_b32 s63, s63, 8
  s_add_u32 s61, s61, s63
  s_and_b32 s63, s62, 1
  s_cselect_b32 s64, 248, 8
  s_lshl_b32 s63, s63, 3
  s_add_u32 s61, s61, s63
  s_add_u32 s44, s61, s30
  s_cmp_eq_u32 s62, 6
  s_cselect_b32 s45, 256, s64
  s_lshl_b32 s60, s21, 4
  s_add_u32 s60, s60, 14
  s_mul_i32 s61, s60, 147
  s_lshr_b32 s61, s61, 10
  s_mul_i32 s62, s61, 7
  s_sub_u32 s62, s60, s62
  s_lshl_b32 s61, s61, 10
  s_lshr_b32 s63, s62, 1
  s_lshl_b32 s63, s63, 8
  s_add_u32 s61, s61, s63
  s_and_b32 s63, s62, 1
  s_cselect_b32 s64, 248, 8
  s_lshl_b32 s63, s63, 3
  s_add_u32 s61, s61, s63
  s_add_u32 s46, s61, s30
  s_cmp_eq_u32 s62, 6
  s_cselect_b32 s47, 256, s64
  v_and_b32 v3, 15, v0
  v_lshlrev_b32 v3, 4, v3
  v_bfe_u32 v9, v0, 4, 1
  v_lshl_add_u32 v3, v9, 14, v3
  v_mad_u32_u24 v4, v18, s33, v3
  s_add_u32 s33, s32, 32768
  v_mad_u32_u24 v5, v18, s35, v3
  s_add_u32 s35, s34, 32768
  v_mad_u32_u24 v6, v18, s37, v3
  s_add_u32 s37, s36, 32768
  v_mad_u32_u24 v7, v18, s39, v3
  s_add_u32 s39, s38, 32768
  v_mad_u32_u24 v8, v18, s41, v3
  s_add_u32 s41, s40, 32768
  v_mad_u32_u24 v9, v18, s43, v3
  s_add_u32 s43, s42, 32768
  v_mad_u32_u24 v10, v18, s45, v3
  s_add_u32 s45, s44, 32768
  v_mad_u32_u24 v11, v18, s47, v3
  s_add_u32 s47, s46, 32768
  s_mov_b32 s27, 0
  s_mov_b32 s28, 0
  s_mov_b32 s29, 40960
  s_setprio 2
  s_mov_b32 s69, 0
Lpoll9:
  ds_read_b32 v3, v2 offset:0
  s_add_u32 s69, s69, 1
  s_cmp_gt_u32 s69, 0x100000
  s_cbranch_scc1 Lpoll9_x
  s_waitcnt lgkmcnt(0)
  v_readfirstlane_b32 s68, v3
  s_cmp_ge_u32 s68, 2
  s_cbranch_scc1 Lpoll9_x
  s_branch Lpoll9
Lpoll9_x:
  s_waitcnt lgkmcnt(0)
  ds_read_b128 v[96:99], v12 offset:0
  ds_read_b128 v[100:103], v12 offset:4096
  ds_read_b64_tr_b16 v[88:89], v16 offset:0
  ds_read_b64_tr_b16 v[90:91], v16 offset:512
  ds_read_b64_tr_b16 v[92:93], v17 offset:0
  ds_read_b64_tr_b16 v[94:95], v17 offset:512
L1_q_g_top:
  ds_read_b128 v[112:115], v13 offset:0
  ds_read_b128 v[116:119], v13 offset:4096
  ds_read_b64_tr_b16 v[104:105], v16 offset:2048
  ds_read_b64_tr_b16 v[106:107], v16 offset:2560
  ds_read_b64_tr_b16 v[108:109], v17 offset:2048
  ds_read_b64_tr_b16 v[110:111], v17 offset:2560
  s_waitcnt lgkmcnt(6)
  s_nop 0
  v_mfma_f32_32x32x16_bf16 v[20:35], v[88:91], v[96:99], v[20:35]
  v_mfma_f32_32x32x16_bf16 v[36:51], v[92:95], v[96:99], v[36:51]
  v_mfma_f32_32x32x16_bf16 v[52:67], v[88:91], v[100:103], v[52:67]
  v_mfma_f32_32x32x16_bf16 v[68:83], v[92:95], v[100:103], v[68:83]
  ds_read_b128 v[96:99], v14 offset:0
  ds_read_b128 v[100:103], v14 offset:4096
  ds_read_b64_tr_b16 v[88:89], v16 offset:4096
  ds_read_b64_tr_b16 v[90:91], v16 offset:4608
  ds_read_b64_tr_b16 v[92:93], v17 offset:4096
  ds_read_b64_tr_b16 v[94:95], v17 offset:4608
  s_waitcnt lgkmcnt(6)
  s_nop 0
  v_mfma_f32_32x32x16_bf16 v[20:35], v[104:107], v[112:115], v[20:35]
  v_mfma_f32_32x32x16_bf16 v[36:51], v[108:111], v[112:115], v[36:51]
  v_mfma_f32_32x32x16_bf16 v[52:67], v[104:107], v[116:119], v[52:67]
  v_mfma_f32_32x32x16_bf16 v[68:83], v[108:111], v[116:119], v[68:83]
  ds_read_b128 v[112:115], v15 offset:0
  ds_read_b128 v[116:119], v15 offset:4096
  ds_read_b64_tr_b16 v[104:105], v16 offset:6144
  ds_read_b64_tr_b16 v[106:107], v16 offset:6656
  ds_read_b64_tr_b16 v[108:109], v17 offset:6144
  ds_read_b64_tr_b16 v[110:111], v17 offset:6656
  ds_read_b32 v3, v2 offset:4
  s_waitcnt lgkmcnt(7)
  v_mfma_f32_32x32x16_bf16 v[20:35], v[88:91], v[96:99], v[20:35]
  v_mfma_f32_32x32x16_bf16 v[36:51], v[92:95], v[96:99], v[36:51]
  s_add_u32 s27, s27, 1
  s_add_u32 s28, s28, 1
  s_cmp_eq_u32 s28, 3
  s_cselect_b32 s28, 0, s28
  s_cselect_b32 s60, -81920, s29
  v_add_u32 v12, s60, v12
  v_add_u32 v13, s60, v13
  v_add_u32 v14, s60, v14
  v_add_u32 v15, s60, v15
  v_add_u32 v16, s60, v16
  v_add_u32_e64 v17, s60, v17
  v_mfma_f32_32x32x16_bf16 v[52:67], v[88:91], v[100:103], v[52:67]
  v_mfma_f32_32x32x16_bf16 v[68:83], v[92:95], v[100:103], v[68:83]
  s_waitcnt lgkmcnt(0)
  s_mov_b64 exec, 1
  ds_add_u32 v2, v19 offset:32
  s_mov_b64 exec, -1
L1_q_g_nf:
  v_add_u32 v2, 4, v2
  v_readfirstlane_b32 s68, v3
  s_cmp_eq_u32 s27, 7
  s_cbranch_scc1 L1_q_g_last
  s_cmp_ge_u32 s68, 1
  s_cbranch_scc0 L1_q_g_slow
  s_nop 0
  ds_read_b128 v[96:99], v12 offset:0
  ds_read_b128 v[100:103], v12 offset:4096
  ds_read_b64_tr_b16 v[88:89], v16 offset:0
  ds_read_b64_tr_b16 v[90:91], v16 offset:512
  ds_read_b64_tr_b16 v[92:93], v17 offset:0
  ds_read_b64_tr_b16 v[94:95], v17 offset:512
  v_mfma_f32_32x32x16_bf16 v[20:35], v[104:107], v[112:115], v[20:35]
  v_mfma_f32_32x32x16_bf16 v[36:51], v[108:111], v[112:115], v[36:51]
  v_mfma_f32_32x32x16_bf16 v[52:67], v[104:107], v[116:119], v[52:67]
  v_mfma_f32_32x32x16_bf16 v[68:83], v[108:111], v[116:119], v[68:83]
  s_branch L1_q_g_top
L1_q_g_slow:
  s_nop 0
  v_mfma_f32_32x32x16_bf16 v[20:35], v[104:107], v[112:115], v[20:35]
  v_mfma_f32_32x32x16_bf16 v[36:51], v[108:111], v[112:115], v[36:51]
  v_mfma_f32_32x32x16_bf16 v[52:67], v[104:107], v[116:119], v[52:67]
  v_mfma_f32_32x32x16_bf16 v[68:83], v[108:111], v[116:119], v[68:83]
  s_mov_b32 s69, 0
Lpoll10:
  ds_read_b32 v3, v2 offset:0
  s_add_u32 s69, s69, 1
  s_cmp_gt_u32 s69, 0x100000
  s_cbranch_scc1 Lpoll10_x
  s_waitcnt lgkmcnt(0)
  v_readfirstlane_b32 s68, v3
  s_cmp_ge_u32 s68, 1
  s_cbranch_scc1 Lpoll10_x
  s_branch Lpoll10
Lpoll10_x:
  s_waitcnt lgkmcnt(0)
  s_nop 0
  ds_read_b128 v[96:99], v12 offset:0
  ds_read_b128 v[100:103], v12 offset:4096
  ds_read_b64_tr_b16 v[88:89], v16 offset:0
  ds_read_b64_tr_b16 v[90:91], v16 offset:512
  ds_read_b64_tr_b16 v[92:93], v17 offset:0
  ds_read_b64_tr_b16 v[94:95], v17 offset:512
  s_branch L1_q_g_top
L1_q_g_last:
  s_nop 0
  v_mfma_f32_32x32x16_bf16 v[20:35], v[104:107], v[112:115], v[20:35]
  v_mfma_f32_32x32x16_bf16 v[36:51], v[108:111], v[112:115], v[36:51]
  v_mfma_f32_32x32x16_bf16 v[52:67], v[104:107], v[116:119], v[52:67]
  v_mfma_f32_32x32x16_bf16 v[68:83], v[108:111], v[116:119], v[68:83]
  s_setprio 0
  v_mov_b32 v2, 0x358637bd
  s_nop 6
  v_pk_fma_f32 v[88:89], v[20:21], v[84:85], v[86:87]
  v_pk_fma_f32 v[90:91], v[22:23], v[84:85], v[86:87]
  v_pk_fma_f32 v[92:93], v[24:25], v[84:85], v[86:87]
  v_pk_fma_f32 v[94:95], v[26:27], v[84:85], v[86:87]
  v_exp_f32_e64 v88, v88 clamp
  v_max_f32_e64 v20, v2, v20
  v_exp_f32_e64 v89, v89 clamp
  v_max_f32_e64 v21, v2, v21
  v_exp_f32_e64 v90, v90 clamp
  v_max_f32_e64 v22, v2, v22
  v_exp_f32_e64 v91, v91 clamp
  v_max_f32_e64 v23, v2, v23
  v_exp_f32_e64 v92, v92 clamp
  v_max_f32_e64 v24, v2, v24
  v_exp_f32_e64 v93, v93 clamp
  v_max_f32_e64 v25, v2, v25
  v_exp_f32_e64 v94, v94 clamp
  v_max_f32_e64 v26, v2, v26
  v_exp_f32_e64 v95, v95 clamp
  v_max_f32_e64 v27, v2, v27
  v_pk_add_f32 v[20:21], v[20:21], v[88:89]
  v_pk_add_f32 v[22:23], v[22:23], v[90:91]
  v_pk_add_f32 v[24:25], v[24:25], v[92:93]
  v_pk_add_f32 v[26:27], v[26:27], v[94:95]
  v_cvt_pk_bf16_f32 v96, v20, v21
  v_cvt_pk_bf16_f32 v97, v22, v23
  v_cvt_pk_bf16_f32 v98, v24, v25
  v_cvt_pk_bf16_f32 v99, v26, v27
  buffer_store_dwordx2 v[96:97], v4, s[12:15], s32 offen sc1
  buffer_store_dwordx2 v[98:99], v5, s[12:15], s34 offen sc1
  v_pk_fma_f32 v[88:89], v[28:29], v[84:85], v[86:87]
  v_pk_fma_f32 v[90:91], v[30:31], v[84:85], v[86:87]
  v_pk_fma_f32 v[92:93], v[32:33], v[84:85], v[86:87]
  v_pk_fma_f32 v[94:95], v[34:35], v[84:85], v[86:87]
  v_exp_f32_e64 v88, v88 clamp
  v_max_f32_e64 v28, v2, v28
  v_exp_f32_e64 v89, v89 clamp
  v_max_f32_e64 v29, v2, v29
  v_exp_f32_e64 v90, v90 clamp
  v_max_f32_e64 v30, v2, v30
  v_exp_f32_e64 v91, v91 clamp
  v_max_f32_e64 v31, v2, v31
  v_exp_f32_e64 v92, v92 clamp
  v_max_f32_e64 v32, v2, v32
  v_exp_f32_e64 v93, v93 clamp
  v_max_f32_e64 v33, v2, v33
  v_exp_f32_e64 v94, v94 clamp
  v_max_f32_e64 v34, v2, v34
  v_exp_f32_e64 v95, v95 clamp
  v_max_f32_e64 v35, v2, v35
  v_pk_add_f32 v[28:29], v[28:29], v[88:89]
  v_pk_add_f32 v[30:31], v[30:31], v[90:91]
  v_pk_add_f32 v[32:33], v[32:33], v[92:93]
  v_pk_add_f32 v[34:35], v[34:35], v[94:95]
  v_cvt_pk_bf16_f32 v100, v28, v29
  v_cvt_pk_bf16_f32 v101, v30, v31
  v_cvt_pk_bf16_f32 v102, v32, v33
  v_cvt_pk_bf16_f32 v103, v34, v35
  buffer_store_dwordx2 v[100:101], v6, s[12:15], s36 offen sc1
  buffer_store_dwordx2 v[102:103], v7, s[12:15], s38 offen sc1
  v_pk_fma_f32 v[88:89], v[36:37], v[84:85], v[86:87]
  v_pk_fma_f32 v[90:91], v[38:39], v[84:85], v[86:87]
  v_pk_fma_f32 v[92:93], v[40:41], v[84:85], v[86:87]
  v_pk_fma_f32 v[94:95], v[42:43], v[84:85], v[86:87]
  v_exp_f32_e64 v88, v88 clamp
  v_max_f32_e64 v36, v2, v36
  v_exp_f32_e64 v89, v89 clamp
  v_max_f32_e64 v37, v2, v37
  v_exp_f32_e64 v90, v90 clamp
  v_max_f32_e64 v38, v2, v38
  v_exp_f32_e64 v91, v91 clamp
  v_max_f32_e64 v39, v2, v39
  v_exp_f32_e64 v92, v92 clamp
  v_max_f32_e64 v40, v2, v40
  v_exp_f32_e64 v93, v93 clamp
  v_max_f32_e64 v41, v2, v41
  v_exp_f32_e64 v94, v94 clamp
  v_max_f32_e64 v42, v2, v42
  v_exp_f32_e64 v95, v95 clamp
  v_max_f32_e64 v43, v2, v43
  v_pk_add_f32 v[36:37], v[36:37], v[88:89]
  v_pk_add_f32 v[38:39], v[38:39], v[90:91]
  v_pk_add_f32 v[40:41], v[40:41], v[92:93]
  v_pk_add_f32 v[42:43], v[42:43], v[94:95]
  v_cvt_pk_bf16_f32 v104, v36, v37
  v_cvt_pk_bf16_f32 v105, v38, v39
  v_cvt_pk_bf16_f32 v106, v40, v41
  v_cvt_pk_bf16_f32 v107, v42, v43
  buffer_store_dwordx2 v[104:105], v8, s[12:15], s40 offen sc1
  buffer_store_dwordx2 v[106:107], v9, s[12:15], s42 offen sc1
  v_pk_fma_f32 v[88:89], v[44:45], v[84:85], v[86:87]
  v_pk_fma_f32 v[90:91], v[46:47], v[84:85], v[86:87]
  v_pk_fma_f32 v[92:93], v[48:49], v[84:85], v[86:87]
  v_pk_fma_f32 v[94:95], v[50:51], v[84:85], v[86:87]
  v_exp_f32_e64 v88, v88 clamp
  v_max_f32_e64 v44, v2, v44
  v_exp_f32_e64 v89, v89 clamp
  v_max_f32_e64 v45, v2, v45
  v_exp_f32_e64 v90, v90 clamp
  v_max_f32_e64 v46, v2, v46
  v_exp_f32_e64 v91, v91 clamp
  v_max_f32_e64 v47, v2, v47
  v_exp_f32_e64 v92, v92 clamp
  v_max_f32_e64 v48, v2, v48
  v_exp_f32_e64 v93, v93 clamp
  v_max_f32_e64 v49, v2, v49
  v_exp_f32_e64 v94, v94 clamp
  v_max_f32_e64 v50, v2, v50
  v_exp_f32_e64 v95, v95 clamp
  v_max_f32_e64 v51, v2, v51
  v_pk_add_f32 v[44:45], v[44:45], v[88:89]
  v_pk_add_f32 v[46:47], v[46:47], v[90:91]
  v_pk_add_f32 v[48:49], v[48:49], v[92:93]
  v_pk_add_f32 v[50:51], v[50:51], v[94:95]
  v_cvt_pk_bf16_f32 v108, v44, v45
  v_cvt_pk_bf16_f32 v109, v46, v47
  v_cvt_pk_bf16_f32 v110, v48, v49
  v_cvt_pk_bf16_f32 v111, v50, v51
  buffer_store_dwordx2 v[108:109], v10, s[12:15], s44 offen sc1
  buffer_store_dwordx2 v[110:111], v11, s[12:15], s46 offen sc1
  v_pk_fma_f32 v[88:89], v[52:53], v[84:85], v[86:87]
  v_pk_fma_f32 v[90:91], v[54:55], v[84:85], v[86:87]
  v_pk_fma_f32 v[92:93], v[56:57], v[84:85], v[86:87]
  v_pk_fma_f32 v[94:95], v[58:59], v[84:85], v[86:87]
  v_exp_f32_e64 v88, v88 clamp
  v_max_f32_e64 v52, v2, v52
  v_exp_f32_e64 v89, v89 clamp
  v_max_f32_e64 v53, v2, v53
  v_exp_f32_e64 v90, v90 clamp
  v_max_f32_e64 v54, v2, v54
  v_exp_f32_e64 v91, v91 clamp
  v_max_f32_e64 v55, v2, v55
  v_exp_f32_e64 v92, v92 clamp
  v_max_f32_e64 v56, v2, v56
  v_exp_f32_e64 v93, v93 clamp
  v_max_f32_e64 v57, v2, v57
  v_exp_f32_e64 v94, v94 clamp
  v_max_f32_e64 v58, v2, v58
  v_exp_f32_e64 v95, v95 clamp
  v_max_f32_e64 v59, v2, v59
  v_pk_add_f32 v[52:53], v[52:53], v[88:89]
  v_pk_add_f32 v[54:55], v[54:55], v[90:91]
  v_pk_add_f32 v[56:57], v[56:57], v[92:93]
  v_pk_add_f32 v[58:59], v[58:59], v[94:95]
  v_cvt_pk_bf16_f32 v96, v52, v53
  v_cvt_pk_bf16_f32 v97, v54, v55
  v_cvt_pk_bf16_f32 v98, v56, v57
  v_cvt_pk_bf16_f32 v99, v58, v59
  buffer_store_dwordx2 v[96:97], v4, s[12:15], s33 offen sc1
  buffer_store_dwordx2 v[98:99], v5, s[12:15], s35 offen sc1
  v_pk_fma_f32 v[88:89], v[60:61], v[84:85], v[86:87]
  v_pk_fma_f32 v[90:91], v[62:63], v[84:85], v[86:87]
  v_pk_fma_f32 v[92:93], v[64:65], v[84:85], v[86:87]
  v_pk_fma_f32 v[94:95], v[66:67], v[84:85], v[86:87]
  v_exp_f32_e64 v88, v88 clamp
  v_max_f32_e64 v60, v2, v60
  v_exp_f32_e64 v89, v89 clamp
  v_max_f32_e64 v61, v2, v61
  v_exp_f32_e64 v90, v90 clamp
  v_max_f32_e64 v62, v2, v62
  v_exp_f32_e64 v91, v91 clamp
  v_max_f32_e64 v63, v2, v63
  v_exp_f32_e64 v92, v92 clamp
  v_max_f32_e64 v64, v2, v64
  v_exp_f32_e64 v93, v93 clamp
  v_max_f32_e64 v65, v2, v65
  v_exp_f32_e64 v94, v94 clamp
  v_max_f32_e64 v66, v2, v66
  v_exp_f32_e64 v95, v95 clamp
  v_max_f32_e64 v67, v2, v67
  v_pk_add_f32 v[60:61], v[60:61], v[88:89]
  v_pk_add_f32 v[62:63], v[62:63], v[90:91]
  v_pk_add_f32 v[64:65], v[64:65], v[92:93]
  v_pk_add_f32 v[66:67], v[66:67], v[94:95]
  v_cvt_pk_bf16_f32 v100, v60, v61
  v_cvt_pk_bf16_f32 v101, v62, v63
  v_cvt_pk_bf16_f32 v102, v64, v65
  v_cvt_pk_bf16_f32 v103, v66, v67
  buffer_store_dwordx2 v[100:101], v6, s[12:15], s37 offen sc1
  buffer_store_dwordx2 v[102:103], v7, s[12:15], s39 offen sc1
  v_pk_fma_f32 v[88:89], v[68:69], v[84:85], v[86:87]
  v_pk_fma_f32 v[90:91], v[70:71], v[84:85], v[86:87]
  v_pk_fma_f32 v[92:93], v[72:73], v[84:85], v[86:87]
  v_pk_fma_f32 v[94:95], v[74:75], v[84:85], v[86:87]
  v_exp_f32_e64 v88, v88 clamp
  v_max_f32_e64 v68, v2, v68
  v_exp_f32_e64 v89, v89 clamp
  v_max_f32_e64 v69, v2, v69
  v_exp_f32_e64 v90, v90 clamp
  v_max_f32_e64 v70, v2, v70
  v_exp_f32_e64 v91, v91 clamp
  v_max_f32_e64 v71, v2, v71
  v_exp_f32_e64 v92, v92 clamp
  v_max_f32_e64 v72, v2, v72
  v_exp_f32_e64 v93, v93 clamp
  v_max_f32_e64 v73, v2, v73
  v_exp_f32_e64 v94, v94 clamp
  v_max_f32_e64 v74, v2, v74
  v_exp_f32_e64 v95, v95 clamp
  v_max_f32_e64 v75, v2, v75
  v_pk_add_f32 v[68:69], v[68:69], v[88:89]
  v_pk_add_f32 v[70:71], v[70:71], v[90:91]
  v_pk_add_f32 v[72:73], v[72:73], v[92:93]
  v_pk_add_f32 v[74:75], v[74:75], v[94:95]
  v_cvt_pk_bf16_f32 v104, v68, v69
  v_cvt_pk_bf16_f32 v105, v70, v71
  v_cvt_pk_bf16_f32 v106, v72, v73
  v_cvt_pk_bf16_f32 v107, v74, v75
  buffer_store_dwordx2 v[104:105], v8, s[12:15], s41 offen sc1
  buffer_store_dwordx2 v[106:107], v9, s[12:15], s43 offen sc1
  v_pk_fma_f32 v[88:89], v[76:77], v[84:85], v[86:87]
  v_pk_fma_f32 v[90:91], v[78:79], v[84:85], v[86:87]
  v_pk_fma_f32 v[92:93], v[80:81], v[84:85], v[86:87]
  v_pk_fma_f32 v[94:95], v[82:83], v[84:85], v[86:87]
  v_exp_f32_e64 v88, v88 clamp
  v_max_f32_e64 v76, v2, v76
  v_exp_f32_e64 v89, v89 clamp
  v_max_f32_e64 v77, v2, v77
  v_exp_f32_e64 v90, v90 clamp
  v_max_f32_e64 v78, v2, v78
  v_exp_f32_e64 v91, v91 clamp
  v_max_f32_e64 v79, v2, v79
  v_exp_f32_e64 v92, v92 clamp
  v_max_f32_e64 v80, v2, v80
  v_exp_f32_e64 v93, v93 clamp
  v_max_f32_e64 v81, v2, v81
  v_exp_f32_e64 v94, v94 clamp
  v_max_f32_e64 v82, v2, v82
  v_exp_f32_e64 v95, v95 clamp
  v_max_f32_e64 v83, v2, v83
  v_pk_add_f32 v[76:77], v[76:77], v[88:89]
  v_pk_add_f32 v[78:79], v[78:79], v[90:91]
  v_pk_add_f32 v[80:81], v[80:81], v[92:93]
  v_pk_add_f32 v[82:83], v[82:83], v[94:95]
  v_cvt_pk_bf16_f32 v108, v76, v77
  v_cvt_pk_bf16_f32 v109, v78, v79
  v_cvt_pk_bf16_f32 v110, v80, v81
  v_cvt_pk_bf16_f32 v111, v82, v83
  buffer_store_dwordx2 v[108:109], v10, s[12:15], s45 offen sc1
  buffer_store_dwordx2 v[110:111], v11, s[12:15], s47 offen sc1
  s_endpgm
L1_gk:
  s_sub_u32 s23, s3, 8
  s_lshr_b32 s60, s23, 2
  s_cmp_lt_u32 s29, 16
  s_cbranch_scc0 L1_gk_q
  s_mov_b32 s58, s29
  s_cmp_eq_u32 s60, 0
  s_cbranch_scc1 L1_kgen
  s_endpgm
L1_gk_q:
  s_cmp_eq_u32 s29, 22
  s_cbranch_scc1 L1_end
  s_lshl_b32 s58, s29, 1
  s_sub_u32 s58, s58, 16
  s_add_u32 s58, s58, s60
  s_branch L1_kgen
L1_aux:
  s_mov_b32 s23, s3
  s_lshr_b32 s60, s3, 2
  s_cmp_ge_u32 s29, 28
  s_cbranch_scc1 L1_aux_m
  s_lshl_b32 s58, s29, 2
  s_sub_u32 s58, s58, 64
  s_add_u32 s58, s58, s60
  s_branch L1_kgen
L1_aux_m:
  s_cmp_ge_u32 s3, 8
  s_cbranch_scc1 L1_misc
  s_lshl_b32 s58, s29, 1
  s_sub_u32 s58, s58, 8
  s_add_u32 s58, s58, s60
L1_kgen:
  s_mul_i32 s24, s28, 56
  s_add_u32 s24, s24, s58
  s_lshl_b32 s60, s24, 1
  s_and_b32 s60, s60, 0xfffffffc
  s_load_dword s26, s[48:49], s60
  s_load_dword s27, s[50:51], s60
  s_lshr_b32 s30, s23, 2
  s_lshl_b32 s60, s24, 9
  s_lshl_b32 s61, s22, 7
  s_add_u32 s60, s60, s61
  v_lshl_add_u32 v2, v0, 1, s60
  s_cmp_eq_u32 s59, 0
  s_cbranch_scc1 L1_kg_np
  s_mov_b32 s69, 0
Lpoll11:
  ds_read_b32 v3, v1 offset:64
  s_add_u32 s69, s69, 1
  s_cmp_gt_u32 s69, 0x100000
  s_cbranch_scc1 Lpoll11_x
  s_waitcnt lgkmcnt(0)
  v_readfirstlane_b32 s68, v3
  s_cmp_ge_u32 s68, 1
  s_cbranch_scc1 Lpoll11_x
  s_sleep 2
  s_branch Lpoll11
Lpoll11_x:
  s_waitcnt lgkmcnt(0)
L1_kg_np:
  global_load_ushort v6, v2, s[40:41]
  global_load_ushort v7, v2, s[42:43]
  global_load_ushort v8, v2, s[44:45]
  global_load_ushort v9, v2, s[46:47]
  s_mul_i32 s25, s23, 4352
  s_mov_b32 m0, s25
  s_mul_i32 s31, s30, 17408
  s_mov_b32 s64, 0x3e22f983
  s_mov_b32 s65, 0x31dc9c88
  s_mov_b32 s66, 0x41000000
  s_mov_b32 s67, 0x43000000
  s_waitcnt lgkmcnt(0)
  s_and_b32 s60, s24, 1
  s_lshl_b32 s60, s60, 4
  s_lshr_b32 s26, s26, s60
  s_lshl_b32 s26, s26, 16
  s_lshr_b32 s27, s27, s60
  s_lshl_b32 s27, s27, 16
  v_mov_b32 v2, s26
  v_mul_f32 v4, 0x3fb8aa00, v2
  v_mul_f32 v3, 0x36a407db, v2
  v_exp_f32 v4, v4
  s_nop 0
  v_fma_f32 v4, v4, v3, v4
  v_cvt_pk_bf16_f32 v4, v4, v4
  v_and_b32 v4, 0xffff0000, v4
  s_nop 0
  v_readfirstlane_b32 s26, v4
  s_waitcnt vmcnt(0)
  v_lshlrev_b32 v6, 16, v6
  v_lshlrev_b32 v7, 16, v7
  v_lshlrev_b32 v8, 16, v8
  v_lshlrev_b32_e64 v9, 16, v9
  v_mul_f32 v4, 0x3fb8aa00, v6
  v_mul_f32 v3, 0x36a407db, v6
  v_exp_f32 v4, v4
  s_nop 0
  v_fma_f32 v4, v4, v3, v4
  v_cvt_pk_bf16_f32 v4, v4, v4
  v_and_b32 v4, 0xffff0000, v4
  v_mul_f32 v7, s26, v7
  v_mul_f32 v4, s26, v4
  v_mul_f32_e64 v5, s64, v7
  v_mul_f32 v4, 0xbfb8aa3b, v4
  v_fma_f32 v6, v7, s64, -v5
  v_fma_f32 v6, v7, s65, v6
  v_and_b32 v2, 0x7fffffff, v8
  v_and_b32 v3, 0x7fffffff, v9
  v_max_u32 v2, v2, v3
  v_mul_f32 v102, s66, v4
  v_mul_f32_e64 v103, s66, v5
  v_max_u32_dpp v2, v2, v2 row_shr:1 row_mask:0xf bank_mask:0xf
  v_mov_b32 v104, v4
  v_fract_f32 v105, v5
  v_max_u32_dpp v2, v2, v2 row_shr:2 row_mask:0xf bank_mask:0xf
  v_mul_f32 v106, s67, v4
  v_mul_f32 v107, s67, v5
  v_max_u32_dpp v2, v2, v2 row_shr:4 row_mask:0xf bank_mask:0xf
  v_exp_f32 v102, v102
  v_fract_f32 v103, v103
  v_exp_f32 v104, v104
  v_exp_f32 v106, v106
  v_fract_f32_e64 v107, v107
  v_max_u32_dpp v2, v2, v2 row_shr:8 row_mask:0xf bank_mask:0xf
  v_fma_f32 v103, v6, s66, v103
  v_add_f32_e64 v105, v105, v6
  v_fma_f32 v107, v6, s67, v107
  v_max_u32_dpp v2, v2, v2 row_bcast:15 row_mask:0xa bank_mask:0xf
  v_cos_f32 v108, v103
  v_sin_f32 v109, v103
  v_cos_f32 v84, v105
  v_sin_f32 v85, v105
  v_cos_f32 v98, v107
  v_sin_f32 v99, v107
  v_max_u32_dpp v2, v2, v2 row_bcast:31 row_mask:0xc bank_mask:0xf
  v_mul_f32 v108, v102, v108
  v_mul_f32 v109, v102, v109
  v_mul_f32_e64 v84, v104, v84
  v_mul_f32_e64 v85, v104, -v85
  v_mul_f32_e64 v98, v106, v98
  v_mul_f32_e64 v99, v106, -v99
  v_readlane_b32 s60, v2, 63
  s_lshr_b32 s60, s60, 23
  s_min_u32 s60, s60, 253
  s_lshl_b32 s28, s60, 23
  s_sub_u32 s60, 254, s60
  s_lshl_b32 s60, s60, 23
  v_mul_f32 v68, s60, v8
  v_mul_f32_e64 v69, s60, -v9
  v_mul_f32 v52, v108, v108
  v_mul_f32 v53, v108, v109
  v_mul_f32 v86, v84, v84
  v_mul_f32 v87, v84, v85
  v_mul_f32 v70, v68, v98
  v_mul_f32 v71, v68, v99
  v_mul_f32 v100, v98, v98
  v_mul_f32 v101, v98, v99
  v_fma_f32 v52, -v109, v109, v52
  v_fmac_f32_e64 v53, v109, v108
  v_fma_f32 v86, -v85, v85, v86
  v_fmac_f32_e64 v87, v85, v84
  v_fma_f32 v70, -v69, v99, v70
  v_fmac_f32_e64 v71, v69, v98
  v_fma_f32 v100, -v99, v99, v100
  v_fmac_f32 v101, v99, v98
  v_mul_f32 v54, v52, v108
  v_mul_f32 v55, v52, v109
  v_mul_f32 v56, v52, v52
  v_mul_f32 v57, v52, v53
  v_mul_f32 v88, v86, v84
  v_mul_f32 v89, v86, v85
  v_mul_f32 v90, v86, v86
  v_mul_f32_e64 v91, v86, v87
  v_fma_f32 v54, -v53, v109, v54
  v_fmac_f32_e64 v55, v53, v108
  v_fma_f32 v56, -v53, v53, v56
  v_fmac_f32_e64 v57, v53, v52
  v_fma_f32 v88, -v87, v85, v88
  v_fmac_f32_e64 v89, v87, v84
  v_fma_f32 v90, -v87, v87, v90
  v_fmac_f32_e64 v91, v87, v86
  v_cvt_pk_f16_f32 v12, v108, v109
  v_cvt_pk_f16_f32 v13, v52, v53
  v_cvt_pk_f16_f32 v14, v54, v55
  v_mul_f32 v58, v56, v108
  v_mul_f32 v59, v56, v109
  v_mul_f32 v60, v56, v52
  v_mul_f32 v61, v56, v53
  v_mul_f32 v62, v56, v54
  v_mul_f32 v63, v56, v55
  v_mul_f32 v64, v56, v56
  v_mul_f32 v65, v56, v57
  v_fma_f32 v58, -v57, v109, v58
  v_fmac_f32_e64 v59, v57, v108
  v_fma_f32 v60, -v57, v53, v60
  v_fmac_f32_e64 v61, v57, v52
  v_fma_f32 v62, -v57, v55, v62
  v_fmac_f32_e64 v63, v57, v54
  v_fma_f32 v64, -v57, v57, v64
  v_fmac_f32 v65, v57, v56
  v_mul_f32 v92, v90, v84
  v_mul_f32 v93, v90, v85
  v_mul_f32 v94, v90, v86
  v_mul_f32 v95, v90, v87
  v_mul_f32 v96, v90, v88
  v_mul_f32 v97, v90, v89
  v_mul_f32 v98, v100, v100
  v_mul_f32_e64 v99, v100, v101
  v_fma_f32 v92, -v91, v85, v92
  v_fmac_f32_e64 v93, v91, v84
  v_fma_f32 v94, -v91, v87, v94
  v_fmac_f32_e64 v95, v91, v86
  v_fma_f32 v96, -v91, v89, v96
  v_fmac_f32_e64 v97, v91, v88
  v_fma_f32 v98, -v101, v101, v98
  v_fmac_f32_e64 v99, v101, v100
  v_cvt_pk_f16_f32 v15, v56, v57
  v_cvt_pk_f16_f32 v16, v58, v59
  v_cvt_pk_f16_f32 v17, v60, v61
  v_cvt_pk_f16_f32 v18, v62, v63
  v_cvt_pk_f16_f32 v19, v64, v65
  v_mul_f32 v102, v64, v108
  v_mul_f32 v103, v64, v109
  v_mul_f32 v104, v64, v52
  v_mul_f32 v105, v64, v53
  v_mul_f32 v106, v64, v54
  v_mul_f32 v107, v64, v55
  v_mul_f32 v72, v68, v100
  v_mul_f32 v73, v68, v101
  v_fma_f32 v102, -v65, v109, v102
  v_fmac_f32_e64 v103, v65, v108
  v_fma_f32 v104, -v65, v53, v104
  v_fmac_f32_e64 v105, v65, v52
  v_fma_f32 v106, -v65, v55, v106
  v_fmac_f32_e64 v107, v65, v54
  v_fma_f32 v72, -v69, v101, v72
  v_fmac_f32_e64 v73, v69, v100
  v_cvt_pk_f16_f32 v20, v102, v103
  v_cvt_pk_f16_f32 v21, v104, v105
  v_cvt_pk_f16_f32 v22, v106, v107
  v_mul_f32 v102, v64, v56
  v_mul_f32 v103, v64, v57
  v_mul_f32 v104, v64, v58
  v_mul_f32 v105, v64, v59
  v_mul_f32 v106, v64, v60
  v_mul_f32 v107, v64, v61
  v_mul_f32 v108, v64, v62
  v_mul_f32 v109, v64, v63
  v_fma_f32 v102, -v65, v57, v102
  v_fmac_f32_e64 v103, v65, v56
  v_fma_f32 v104, -v65, v59, v104
  v_fmac_f32_e64 v105, v65, v58
  v_fma_f32 v106, -v65, v61, v106
  v_fmac_f32_e64 v107, v65, v60
  v_fma_f32 v108, -v65, v63, v108
  v_fmac_f32 v109, v65, v62
  v_mul_f32 v74, v70, v100
  v_mul_f32_e64 v75, v70, v101
  v_fma_f32 v74, -v71, v101, v74
  v_fmac_f32_e64 v75, v71, v100
  v_cvt_pk_f16_f32 v23, v102, v103
  v_cvt_pk_f16_f32 v24, v104, v105
  v_cvt_pk_f16_f32 v25, v106, v107
  v_cvt_pk_f16_f32 v26, v108, v109
  v_mul_f32 v102, v68, v84
  v_mul_f32 v103, v68, v85
  v_mul_f32 v104, v68, v86
  v_mul_f32 v105, v68, v87
  v_mul_f32 v106, v68, v88
  v_mul_f32 v107, v68, v89
  v_fma_f32 v102, -v69, v85, v102
  v_fmac_f32_e64 v103, v69, v84
  v_fma_f32 v104, -v69, v87, v104
  v_fmac_f32_e64 v105, v69, v86
  v_fma_f32 v106, -v69, v89, v106
  v_fmac_f32_e64 v107, v69, v88
  v_cvt_pk_f16_f32 v27, v68, v69
  v_cvt_pk_f16_f32 v28, v102, v103
  v_cvt_pk_f16_f32 v29, v104, v105
  v_cvt_pk_f16_f32 v30, v106, v107
  v_mul_f32 v102, v68, v90
  v_mul_f32 v103, v68, v91
  v_mul_f32 v104, v68, v92
  v_mul_f32 v105, v68, v93
  v_mul_f32 v106, v68, v94
  v_mul_f32 v107, v68, v95
  v_mul_f32 v108, v68, v96
  v_mul_f32 v109, v68, v97
  v_fma_f32 v102, -v69, v91, v102
  v_fmac_f32_e64 v103, v69, v90
  v_fma_f32 v104, -v69, v93, v104
  v_fmac_f32_e64 v105, v69, v92
  v_fma_f32 v106, -v69, v95, v106
  v_fmac_f32_e64 v107, v69, v94
  v_fma_f32 v108, -v69, v97, v108
  v_fmac_f32_e64 v109, v69, v96
  v_cvt_pk_f16_f32 v31, v102, v103
  v_cvt_pk_f16_f32 v32, v104, v105
  v_cvt_pk_f16_f32 v33, v106, v107
  v_cvt_pk_f16_f32 v34, v108, v109
  v_mul_f32 v102, v70, v84
  v_mul_f32 v103, v70, v85
  v_mul_f32 v104, v70, v86
  v_mul_f32 v105, v70, v87
  v_mul_f32 v106, v70, v88
  v_mul_f32 v107, v70, v89
  v_fma_f32 v102, -v71, v85, v102
  v_fmac_f32_e64 v103, v71, v84
  v_fma_f32 v104, -v71, v87, v104
  v_fmac_f32_e64 v105, v71, v86
  v_fma_f32 v106, -v71, v89, v106
  v_fmac_f32_e64 v107, v71, v88
  v_cvt_pk_f16_f32 v35, v70, v71
  v_cvt_pk_f16_f32 v36, v102, v103
  v_cvt_pk_f16_f32 v37, v104, v105
  v_cvt_pk_f16_f32 v38, v106, v107
  v_mul_f32 v102, v70, v90
  v_mul_f32 v103, v70, v91
  v_mul_f32 v104, v70, v92
  v_mul_f32 v105, v70, v93
  v_mul_f32 v106, v70, v94
  v_mul_f32 v107, v70, v95
  v_mul_f32 v108, v70, v96
  v_mul_f32 v109, v70, v97
  v_fma_f32 v102, -v71, v91, v102
  v_fmac_f32_e64 v103, v71, v90
  v_fma_f32 v104, -v71, v93, v104
  v_fmac_f32_e64 v105, v71, v92
  v_fma_f32 v106, -v71, v95, v106
  v_fmac_f32_e64 v107, v71, v94
  v_fma_f32 v108, -v71, v97, v108
  v_fmac_f32_e64 v109, v71, v96
  v_cvt_pk_f16_f32 v39, v102, v103
  v_cvt_pk_f16_f32 v40, v104, v105
  v_cvt_pk_f16_f32 v41, v106, v107
  v_cvt_pk_f16_f32 v42, v108, v109
  v_mul_f32 v76, v68, v98
  v_mul_f32 v77, v68, v99
  v_mul_f32 v78, v70, v98
  v_mul_f32 v79, v70, v99
  v_mul_f32 v80, v72, v98
  v_mul_f32 v81, v72, v99
  v_mul_f32 v82, v74, v98
  v_mul_f32 v83, v74, v99
  v_fma_f32 v76, -v69, v99, v76
  v_fmac_f32_e64 v77, v69, v98
  v_fma_f32 v78, -v71, v99, v78
  v_fmac_f32_e64 v79, v71, v98
  v_fma_f32 v80, -v73, v99, v80
  v_fmac_f32_e64 v81, v73, v98
  v_fma_f32 v82, -v75, v99, v82
  v_fmac_f32 v83, v75, v98
  v_mul_f32 v100, v98, v98
  v_mul_f32 v101, v98, v99
  v_mul_f32 v102, v72, v86
  v_mul_f32 v103, v72, v87
  v_mul_f32 v104, v72, v90
  v_mul_f32 v105, v72, v91
  v_mul_f32 v106, v72, v94
  v_mul_f32_e64 v107, v72, v95
  v_fma_f32 v100, -v99, v99, v100
  v_fmac_f32_e64 v101, v99, v98
  v_fma_f32 v102, -v73, v87, v102
  v_fmac_f32_e64 v103, v73, v86
  v_fma_f32 v104, -v73, v91, v104
  v_fmac_f32_e64 v105, v73, v90
  v_fma_f32 v106, -v73, v95, v106
  v_fmac_f32_e64 v107, v73, v94
  v_cvt_pk_f16_f32 v43, v72, v73
  v_cvt_pk_f16_f32 v44, v102, v103
  v_cvt_pk_f16_f32 v45, v104, v105
  v_cvt_pk_f16_f32 v46, v106, v107
  v_mul_f32 v102, v74, v86
  v_mul_f32 v103, v74, v87
  v_mul_f32 v104, v74, v90
  v_mul_f32 v105, v74, v91
  v_mul_f32 v106, v74, v94
  v_mul_f32 v107, v74, v95
  v_fma_f32 v102, -v75, v87, v102
  v_fmac_f32_e64 v103, v75, v86
  v_fma_f32 v104, -v75, v91, v104
  v_fmac_f32_e64 v105, v75, v90
  v_fma_f32 v106, -v75, v95, v106
  v_fmac_f32_e64 v107, v75, v94
  v_cvt_pk_f16_f32 v47, v74, v75
  v_cvt_pk_f16_f32 v48, v102, v103
  v_cvt_pk_f16_f32 v49, v104, v105
  v_cvt_pk_f16_f32 v50, v106, v107
  v_mul_f32 v102, v76, v90
  v_mul_f32 v103, v76, v91
  v_mul_f32 v104, v78, v90
  v_mul_f32 v105, v78, v91
  v_mul_f32 v106, v80, v90
  v_mul_f32 v107, v80, v91
  v_mul_f32 v108, v82, v90
  v_mul_f32 v109, v82, v91
  v_fma_f32 v102, -v77, v91, v102
  v_fmac_f32_e64 v103, v77, v90
  v_fma_f32 v104, -v79, v91, v104
  v_fmac_f32_e64 v105, v79, v90
  v_fma_f32 v106, -v81, v91, v106
  v_fmac_f32_e64 v107, v81, v90
  v_fma_f32 v108, -v83, v91, v108
  v_fmac_f32_e64 v109, v83, v90
  v_cvt_pk_f16_f32 v51, v76, v77
  v_cvt_pk_f16_f32 v52, v102, v103
  v_cvt_pk_f16_f32 v53, v78, v79
  v_cvt_pk_f16_f32 v54, v104, v105
  v_cvt_pk_f16_f32 v55, v80, v81
  v_cvt_pk_f16_f32 v56, v106, v107
  v_cvt_pk_f16_f32 v57, v82, v83
  v_cvt_pk_f16_f32 v58, v108, v109
  v_mul_f32 v84, v68, v100
  v_mul_f32 v85, v68, v101
  v_mul_f32 v102, v70, v100
  v_mul_f32 v103, v70, v101
  v_mul_f32 v104, v72, v100
  v_mul_f32 v105, v72, v101
  v_mul_f32 v106, v74, v100
  v_mul_f32 v107, v74, v101
  v_fma_f32 v84, -v69, v101, v84
  v_fmac_f32_e64 v85, v69, v100
  v_fma_f32 v102, -v71, v101, v102
  v_fmac_f32_e64 v103, v71, v100
  v_fma_f32 v104, -v73, v101, v104
  v_fmac_f32_e64 v105, v73, v100
  v_fma_f32 v106, -v75, v101, v106
  v_fmac_f32 v107, v75, v100
  v_mul_f32 v86, v76, v100
  v_mul_f32 v87, v76, v101
  v_mul_f32 v88, v78, v100
  v_mul_f32 v89, v78, v101
  v_mul_f32 v90, v80, v100
  v_mul_f32 v91, v80, v101
  v_mul_f32 v92, v82, v100
  v_mul_f32_e64 v93, v82, v101
  v_fma_f32 v86, -v77, v101, v86
  v_fmac_f32_e64 v87, v77, v100
  v_fma_f32 v88, -v79, v101, v88
  v_fmac_f32_e64 v89, v79, v100
  v_fma_f32 v90, -v81, v101, v90
  v_fmac_f32_e64 v91, v81, v100
  v_fma_f32 v92, -v83, v101, v92
  v_fmac_f32 v93, v83, v100
  v_mul_f32 v94, v84, v100
  v_mul_f32_e64 v95, v84, v101
  v_fma_f32 v94, -v85, v101, v94
  v_fmac_f32_e64 v95, v85, v100
  v_cvt_pk_f16_f32 v59, v84, v85
  v_cvt_pk_f16_f32 v60, v102, v103
  v_cvt_pk_f16_f32 v61, v104, v105
  v_cvt_pk_f16_f32 v62, v106, v107
  v_cvt_pk_f16_f32 v63, v86, v87
  v_cvt_pk_f16_f32 v64, v88, v89
  v_cvt_pk_f16_f32 v65, v90, v91
  v_cvt_pk_f16_f32 v66, v92, v93
  v_cvt_pk_f16_f32 v67, v94, v95
  v_and_b32 v2, 15, v0
  v_lshrrev_b32 v3, 4, v0
  v_mul_u32_u24 v4, 272, v2
  v_lshl_add_u32 v4, v3, 4, v4
  v_add_u32 v6, s25, v4
  v_lshlrev_b32 v8, 2, v0
  v_lshlrev_b32_e64 v7, 4, v0
  v_mov_b32 v5, 0x3c00
  s_cmp_eq_u32 s59, 0
  s_cbranch_scc1 L1_kg_nw
  s_mov_b32 s69, 0
Lpoll12:
  ds_read_b32 v2, v1 offset:20
  s_add_u32 s69, s69, 1
  s_cmp_gt_u32 s69, 0x100000
  s_cbranch_scc1 Lpoll12_x
  s_waitcnt lgkmcnt(0)
  v_readfirstlane_b32 s68, v2
  s_cmp_ge_u32 s68, 1
  s_cbranch_scc1 Lpoll12_x
  s_sleep 2
  s_branch Lpoll12
Lpoll12_x:
  s_waitcnt lgkmcnt(0)
  s_mov_b32 s69, 0
Lpoll13:
  ds_read_b32 v2, v1 offset:24
  s_add_u32 s69, s69, 1
  s_cmp_gt_u32 s69, 0x100000
  s_cbranch_scc1 Lpoll13_x
  s_waitcnt lgkmcnt(0)
  v_readfirstlane_b32 s68, v2
  s_cmp_ge_u32 s68, 1
  s_cbranch_scc1 Lpoll13_x
  s_sleep 2
  s_branch Lpoll13
Lpoll13_x:
  s_waitcnt lgkmcnt(0)
L1_kg_nw:
  ds_write_addtid_b32 v5
  ds_write_addtid_b32 v12 offset:272
  ds_write_addtid_b32 v13 offset:544
  ds_write_addtid_b32 v14 offset:816
  ds_write_addtid_b32 v15 offset:1088
  ds_write_addtid_b32 v16 offset:1360
  ds_write_addtid_b32 v17 offset:1632
  ds_write_addtid_b32 v18 offset:1904
  ds_write_addtid_b32 v19 offset:2176
  ds_write_addtid_b32 v20 offset:2448
  ds_write_addtid_b32 v21 offset:2720
  ds_write_addtid_b32 v22 offset:2992
  ds_write_addtid_b32 v23 offset:3264
  ds_write_addtid_b32 v24 offset:3536
  ds_write_addtid_b32 v25 offset:3808
  ds_write_addtid_b32 v26 offset:4080
  ds_read_b128 v[68:71], v6 offset:0
  ds_read_b128 v[72:75], v6 offset:64
  ds_read_b128 v[76:79], v6 offset:128
  ds_read_b128 v[80:83], v6 offset:192
  ds_write_addtid_b32 v27 offset:0
  ds_write_addtid_b32 v28 offset:272
  ds_write_addtid_b32 v29 offset:544
  ds_write_addtid_b32 v30 offset:816
  ds_write_addtid_b32 v31 offset:1088
  ds_write_addtid_b32 v32 offset:1360
  ds_write_addtid_b32 v33 offset:1632
  ds_write_addtid_b32 v34 offset:1904
  ds_write_addtid_b32 v35 offset:2176
  ds_write_addtid_b32 v36 offset:2448
  ds_write_addtid_b32 v37 offset:2720
  ds_write_addtid_b32 v38 offset:2992
  ds_write_addtid_b32 v39 offset:3264
  ds_write_addtid_b32 v40 offset:3536
  ds_write_addtid_b32 v41 offset:3808
  ds_write_addtid_b32 v42 offset:4080
  ds_read_b128 v[84:87], v6 offset:0
  ds_read_b128 v[88:91], v6 offset:64
  ds_read_b128 v[92:95], v6 offset:128
  ds_read_b128 v[96:99], v6 offset:192
  ds_write_addtid_b32 v43 offset:0
  ds_write_addtid_b32 v44 offset:272
  ds_write_addtid_b32 v45 offset:544
  ds_write_addtid_b32 v46 offset:816
  ds_write_addtid_b32 v47 offset:1088
  ds_write_addtid_b32 v48 offset:1360
  ds_write_addtid_b32 v49 offset:1632
  ds_write_addtid_b32 v50 offset:1904
  ds_write_addtid_b32 v51 offset:2176
  ds_write_addtid_b32 v52 offset:2448
  ds_write_addtid_b32 v53 offset:2720
  ds_write_addtid_b32 v54 offset:2992
  ds_write_addtid_b32 v55 offset:3264
  ds_write_addtid_b32 v56 offset:3536
  ds_write_addtid_b32 v57 offset:3808
  ds_write_addtid_b32 v58 offset:4080
  ds_read_b128 v[12:15], v6 offset:0
  ds_read_b128 v[16:19], v6 offset:64
  ds_read_b128 v[20:23], v6 offset:128
  ds_read_b128 v[24:27], v6 offset:192
  s_waitcnt lgkmcnt(4)
  s_nop 0
  v_mfma_f32_16x16x32_f16 v[100:103], v[84:87], v[68:71], 0
  v_mfma_f32_16x16x32_f16 v[100:103], v[88:91], v[72:75], v[100:103]
  v_mfma_f32_16x16x32_f16 v[100:103], v[92:95], v[76:79], v[100:103]
  v_mfma_f32_16x16x32_f16 v[100:103], v[96:99], v[80:83], v[100:103]
  ds_write_addtid_b32 v59 offset:0
  ds_write_addtid_b32 v60 offset:272
  ds_write_addtid_b32 v61 offset:544
  ds_write_addtid_b32 v62 offset:816
  ds_write_addtid_b32 v63 offset:1088
  ds_write_addtid_b32 v64 offset:1360
  ds_write_addtid_b32 v65 offset:1632
  ds_write_addtid_b32 v66 offset:1904
  ds_write_addtid_b32 v67 offset:2176
  ds_read_b128 v[28:31], v6 offset:0
  ds_read_b128 v[32:35], v6 offset:64
  ds_read_b128 v[36:39], v6 offset:128
  ds_read_b128 v[40:43], v6 offset:192
  s_waitcnt lgkmcnt(13)
  s_nop 0
  v_mfma_f32_16x16x32_f16 v[104:107], v[12:15], v[68:71], 0
  v_mfma_f32_16x16x32_f16 v[104:107], v[16:19], v[72:75], v[104:107]
  v_mfma_f32_16x16x32_f16 v[104:107], v[20:23], v[76:79], v[104:107]
  v_mfma_f32_16x16x32_f16 v[104:107], v[24:27], v[80:83], v[104:107]
  v_add_u32 v4, s25, v7
  s_waitcnt lgkmcnt(0)
  v_mfma_f32_16x16x32_f16 v[108:111], v[28:31], v[68:71], 0
  v_mfma_f32_16x16x32_f16 v[108:111], v[32:35], v[72:75], v[108:111]
  v_mfma_f32_16x16x32_f16 v[108:111], v[36:39], v[76:79], v[108:111]
  v_mfma_f32_16x16x32_f16 v[108:111], v[40:43], v[80:83], v[108:111]
  v_mul_f32 v100, s28, v100
  v_mul_f32 v101, s28, v101
  v_mul_f32 v102, s28, v102
  v_mul_f32 v103, s28, v103
  ds_write_b128 v4, v[100:103] offset:0
  v_mul_f32 v104, s28, v104
  v_mul_f32 v105, s28, v105
  v_mul_f32 v106, s28, v106
  v_mul_f32 v107, s28, v107
  ds_write_b128 v4, v[104:107] offset:1024
  v_mul_f32 v108, s28, v108
  v_mul_f32 v109, s28, v109
  v_mul_f32 v110, s28, v110
  v_mul_f32 v111, s28, v111
  ds_write_b128 v4, v[108:111] offset:2048
  s_lshl_b32 s60, s30, 2
  v_add_u32 v3, s60, v1
  v_mov_b32 v2, 1
  s_mov_b64 exec, 1
  ds_add_rtn_u32 v2, v3, v2 offset:108
  s_mov_b64 exec, -1
  s_waitcnt lgkmcnt(0)
  v_readfirstlane_b32 s60, v2
  s_cmp_eq_u32 s60, 3
  s_cbranch_scc0 L1_kg_end
  s_setprio 3
  v_add_u32_e64 v4, s31, v7
  ds_read_b128 v[12:15], v4 offset:0
  ds_read_b128 v[16:19], v4 offset:1024
  ds_read_b128 v[20:23], v4 offset:2048
  ds_read_b128 v[24:27], v4 offset:4352
  ds_read_b128 v[28:31], v4 offset:5376
  ds_read_b128 v[32:35], v4 offset:6400
  ds_read_b128 v[36:39], v4 offset:8704
  ds_read_b128 v[40:43], v4 offset:9728
  ds_read_b128 v[44:47], v4 offset:10752
  ds_read_b128 v[48:51], v4 offset:13056
  ds_read_b128 v[52:55], v4 offset:14080
  ds_read_b128 v[56:59], v4 offset:15104
  s_add_u32 s29, s25, 0
  v_and_b32 v2, 15, v0
  v_lshrrev_b32 v3, 4, v0
  v_lshrrev_b32 v4, 1, v3
  v_and_b32 v5, 1, v3
  v_lshlrev_b32 v60, 4, v2
  v_lshl_add_u32 v60, v4, 8, v60
  v_lshl_add_u32 v60, v5, 3, v60
  v_add_u32_e64 v60, s29, v60
  v_cmp_gt_u32 s[60:61], 2, v3
  v_lshlrev_b32 v4, 3, v2
  v_lshlrev_b32 v5, 2, v2
  v_cndmask_b32 v4, v5, v4, s[60:61]
  v_lshl_add_u32 v4, v3, 7, v4
  v_add_u32 v61, s29, v4
  v_mov_b32 v5, 64
  v_cndmask_b32 v5, v5, 4, s[60:61]
  v_add_u32 v62, v61, v5
  v_lshlrev_b32 v4, 1, v2
  v_lshl_add_u32 v4, v3, 7, v4
  v_add_u32 v63, s29, v4
  v_mov_b32 v64, 0
  v_writelane_b32 v64, s27, 0
  v_mov_b32 v5, s26
  v_add_f32 v5, v5, v5
  s_lshl_b32 s63, s24, 2
  s_add_u32 s63, s63, 0x610000
  s_mul_i32 s62, s24, 4224
  s_add_u32 s62, s62, 0x440000
  s_waitcnt lgkmcnt(0)
  v_pk_add_f32 v[12:13], v[12:13], v[24:25]
  v_pk_add_f32 v[36:37], v[36:37], v[48:49]
  v_pk_add_f32 v[14:15], v[14:15], v[26:27]
  v_pk_add_f32 v[38:39], v[38:39], v[50:51]
  v_pk_add_f32 v[16:17], v[16:17], v[28:29]
  v_pk_add_f32 v[40:41], v[40:41], v[52:53]
  v_pk_add_f32 v[18:19], v[18:19], v[30:31]
  v_pk_add_f32 v[42:43], v[42:43], v[54:55]
  v_pk_add_f32 v[20:21], v[20:21], v[32:33]
  v_pk_add_f32 v[44:45], v[44:45], v[56:57]
  v_pk_add_f32 v[22:23], v[22:23], v[34:35]
  v_pk_add_f32 v[46:47], v[46:47], v[58:59]
  v_pk_add_f32 v[12:13], v[12:13], v[36:37]
  v_pk_add_f32 v[14:15], v[14:15], v[38:39]
  v_pk_add_f32 v[16:17], v[16:17], v[40:41]
  v_pk_add_f32 v[18:19], v[18:19], v[42:43]
  v_pk_add_f32 v[20:21], v[20:21], v[44:45]
  v_pk_add_f32 v[22:23], v[22:23], v[46:47]
  v_fma_f32 v12, v12, v5, v64
  v_mul_f32 v13, v13, v5
  v_mul_f32 v14, v14, v5
  v_mul_f32 v15, v15, v5
  v_mul_f32 v16, v16, v5
  v_mul_f32 v17, v17, v5
  v_mul_f32 v18, v18, v5
  v_mul_f32 v19, v19, v5
  v_mul_f32 v20, v20, v5
  v_mul_f32 v21, v21, v5
  v_mul_f32 v22, v22, v5
  v_mul_f32_e64 v23, v23, v5
  v_max3_f32 v24, |v12|, |v13|, |v14|
  v_max3_f32 v25, |v15|, |v16|, |v17|
  v_max3_f32 v26, |v18|, |v19|, |v20|
  v_max3_f32 v27, |v21|, |v22|, |v23|
  v_max3_f32 v2, v24, v25, v26
  v_max_f32 v2, v2, v27
  s_nop 1
  v_max_u32_dpp v2, v2, v2 row_shr:1 row_mask:0xf bank_mask:0xf
  s_nop 1
  v_max_u32_dpp v2, v2, v2 row_shr:2 row_mask:0xf bank_mask:0xf
  s_nop 1
  v_max_u32_dpp v2, v2, v2 row_shr:4 row_mask:0xf bank_mask:0xf
  s_nop 1
  v_max_u32_dpp v2, v2, v2 row_shr:8 row_mask:0xf bank_mask:0xf
  s_nop 1
  v_max_u32_dpp v2, v2, v2 row_bcast:15 row_mask:0xa bank_mask:0xf
  s_nop 1
  v_max_u32_dpp v2, v2, v2 row_bcast:31 row_mask:0xc bank_mask:0xf
  s_nop 0
  v_readlane_b32 s60, v2, 63
  s_lshr_b32 s60, s60, 23
  s_max_u32 s60, s60, 13
  s_min_u32 s60, s60, 254
  s_sub_u32 s61, s60, 13
  s_lshl_b32 s61, s61, 23
  s_sub_u32 s60, 267, s60
  s_lshl_b32 s60, s60, 23
  v_mul_f32 v12, s60, v12
  v_mul_f32 v13, s60, v13
  v_mul_f32 v14, s60, v14
  v_mul_f32 v15, s60, v15
  v_mul_f32 v16, s60, v16
  v_mul_f32 v17, s60, v17
  v_mul_f32 v18, s60, v18
  v_mul_f32 v19, s60, v19
  v_mul_f32 v20, s60, v20
  v_mul_f32 v21, s60, v21
  v_mul_f32 v22, s60, v22
  v_mul_f32_e64 v23, s60, v23
  v_cvt_pk_f16_f32 v28, v12, v13
  v_cvt_pk_f16_f32 v29, v14, v15
  v_cvt_pk_f16_f32 v30, v16, v17
  v_cvt_pk_f16_f32 v31, v18, v19
  v_cvt_pk_f16_f32 v32, v20, v21
  v_cvt_pk_f16_f32 v33, v22, v23
  ds_write_b64 v60, v[28:29]
  ds_write_b32 v61, v30 offset:512
  ds_write_b32 v62, v31 offset:512
  ds_write_b16 v63, v32 offset:1024
  ds_write_b16_d16_hi v63, v32 offset:1056
  ds_write_b16 v63, v33 offset:1088
  ds_write_b16_d16_hi v63, v33 offset:1120
  v_add_u32_e64 v2, s29, v7
  ds_read_b128 v[36:39], v2
  v_lshl_add_u32 v3, v0, 3, s29
  ds_read_b64 v[52:53], v3 offset:256
  ds_read_b32 v54, v3 offset:264
  v_add_u32_e64 v4, s29, v8
  ds_read2_b32 v[56:57], v4 offset0:192 offset1:193
  v_lshl_add_u32 v5, v0, 1, s29
  ds_read_u16 v12, v5 offset:1024
  ds_read_u16 v13, v5 offset:1026
  ds_read_u16 v14, v5 offset:1152
  ds_read_u16 v15, v5 offset:1154
  s_mov_b32 s68, 0x01000100
  s_mov_b32 s69, 0x05040302
  s_mov_b32 s70, 0x03020302
  v_and_b32_e64 v2, 1, v0
  v_cmp_eq_u32 s[26:27], 1, v2
  s_waitcnt lgkmcnt(0)
  s_nop 0
  v_perm_b32 v16, v52, v52, s68
  v_perm_b32 v17, v53, v52, s69
  v_perm_b32 v18, v53, v53, s68
  v_perm_b32 v19, v54, v53, s69
  s_mov_b32 exec_lo, 0
  v_mov_b32 v36, v16
  v_mov_b32 v37, v17
  v_mov_b32 v38, v18
  v_mov_b32 v39, v19
  s_mov_b32 exec_lo, -1
  buffer_store_dwordx4 v[36:39], v7, s[12:15], s62 offen offset:64 sc1
  v_perm_b32 v40, v56, v56, s68
  v_mov_b32_e64 v41, v56
  v_perm_b32 v42, v56, v56, s70
  v_perm_b32 v43, v57, v57, s68
  buffer_store_dwordx4 v[40:43], v7, s[12:15], s62 offen offset:1088 sc1
  v_lshl_or_b32 v44, v12, 16, v12
  v_lshl_or_b32 v47, v13, 16, v13
  v_cndmask_b32 v46, v12, v13, s[26:27]
  v_mov_b32_e64 v45, v44
  v_lshl_or_b32 v46, v13, 16, v46
  buffer_store_dwordx4 v[44:47], v7, s[12:15], s62 offen offset:2112 sc1
  v_lshl_or_b32 v48, v14, 16, v14
  v_lshl_or_b32 v51, v15, 16, v15
  v_cndmask_b32 v50, v14, v15, s[26:27]
  v_mov_b32_e64 v49, v48
  v_lshl_or_b32 v50, v15, 16, v50
  buffer_store_dwordx4 v[48:51], v7, s[12:15], s62 offen offset:3136 sc1
  v_mov_b32 v16, 0
  v_mov_b32 v17, 0
  v_mov_b32 v18, 0
  v_mov_b32 v19, 0
  v_mov_b32 v2, s61
  s_mov_b64 exec, 15
  buffer_store_dwordx4 v[16:19], v7, s[12:15], s62 offen sc1
  s_mov_b64 exec, 1
  buffer_store_dword v2, v16, s[12:15], s63 offen sc1
  s_mov_b64 exec, -1
L1_kg_end:
  s_endpgm
L1_misc:
  s_lshl_b32 s58, s28, 2
  s_add_u32 s58, s58, s29
  s_sub_u32 s58, s58, 28
  s_mov_b32 s4, s38
  s_mov_b32 s5, s39
  s_mov_b32 s6, 0x1c0000
  s_mov_b32 s7, 0x20000
  s_mov_b32 s8, s36
  s_mov_b32 s9, s37
  s_mov_b32 s10, 0x62000
  s_mov_b32 s11, 0x20000
  s_mov_b32 s24, s58
  s_sub_u32 s25, s3, 8
  v_lshlrev_b32_e64 v7, 4, v0
  s_mov_b32 exec_hi, 0x00ffffff
  s_lshl_b32 s60, s24, 6
  s_lshl_b32 s61, s25, 3
  s_add_u32 s60, s60, s61
  s_mul_i32 s60, s60, 896
  s_and_b32 s62, s25, 6
  s_lshl_b32 s62, s62, 3
  s_and_b32 s63, s25, 1
  s_lshl_b32 s63, s63, 2
  s_add_u32 s62, s62, s63
  s_mul_i32 s61, s62, 928
  s_add_u32 m0, s61, 36864
  s_nop 0
  s_nop 0
  buffer_load_dwordx4 v7, s[4:7], s60 offen lds
  s_add_u32 m0, s61, 37792
  s_add_u32 s60, s60, 896
  buffer_load_dwordx4 v7, s[4:7], s60 offen lds
  s_add_u32 m0, s61, 38720
  s_add_u32 s60, s60, 896
  buffer_load_dwordx4 v7, s[4:7], s60 offen lds
  s_add_u32 m0, s61, 39648
  s_add_u32 s60, s60, 896
  buffer_load_dwordx4 v7, s[4:7], s60 offen lds
  s_add_u32 m0, s61, 44288
  s_add_u32 s60, s60, 896
  buffer_load_dwordx4 v7, s[4:7], s60 offen lds
  s_add_u32 m0, s61, 45216
  s_add_u32 s60, s60, 896
  buffer_load_dwordx4 v7, s[4:7], s60 offen lds
  s_add_u32 m0, s61, 46144
  s_add_u32 s60, s60, 896
  buffer_load_dwordx4 v7, s[4:7], s60 offen lds
  s_add_u32 m0, s61, 47072
  s_add_u32 s60, s60, 896
  buffer_load_dwordx4 v7, s[4:7], s60 offen lds
  s_cmp_eq_u32 s25, 7
  s_cbranch_scc1 L1_mi_nwo
  s_mul_i32 s60, s24, 14
  s_lshl_b32 s61, s25, 1
  s_add_u32 s60, s60, s61
  s_mul_i32 s60, s60, 896
  s_add_u32 s62, s61, 0
  s_cmp_ge_u32 s62, 7
  s_cselect_b32 s63, 1696, 0
  s_mul_i32 s62, s62, 928
  s_add_u32 s62, s62, s63
  s_add_u32 m0, s62, 98304
  s_add_u32 s63, s60, 0
  buffer_load_dwordx4 v7, s[8:11], s63 offen lds
  s_add_u32 s62, s61, 1
  s_cmp_ge_u32 s62, 7
  s_cselect_b32 s63, 1696, 0
  s_mul_i32 s62, s62, 928
  s_add_u32 s62, s62, s63
  s_add_u32 m0, s62, 98304
  s_add_u32 s63, s60, 896
  buffer_load_dwordx4 v7, s[8:11], s63 offen lds
L1_mi_nwo:
  s_mov_b64 exec, -1
  v_and_b32 v2, 15, v0
  v_lshrrev_b32 v3, 4, v0
  s_cmp_eq_u32 s25, 7
  s_cbranch_scc1 L1_mi_wo
  v_lshrrev_b32 v4, 2, v2
  v_sub_u32 v4, 3, v4
  v_and_b32 v5, 1, v3
  v_xor_b32_e64 v6, 1, v5
  v_lshl_add_u32 v4, v6, 5, v4
  v_mul_u32_u24 v8, 928, v4
  v_and_b32_e64 v6, 3, v2
  v_lshl_add_u32 v8, v6, 3, v8
  v_lshrrev_b32_e64 v4, 1, v3
  v_lshl_add_u32 v8, v4, 5, v8
  s_lshl_b32 s60, s25, 7
  v_add_u32 v8, s60, v8
  v_lshrrev_b32_e64 v9, 2, v2
  v_lshl_add_u32 v9, v4, 2, v9
  v_lshlrev_b32_e64 v9, 14, v9
  v_lshl_add_u32 v9, v5, 6, v9
  v_lshl_add_u32 v9, v6, 4, v9
  s_lshl_b32 s60, s25, 18
  s_add_u32 s60, s60, 0x280f80
  s_lshl_b32 s61, s24, 7
  s_sub_u32 s60, s60, s61
  v_and_b32 v4, 1, v0
  v_cmp_eq_u32 s[26:27], 1, v4
  v_and_b32_e64 v4, 2, v0
  v_cmp_eq_u32 s[28:29], 2, v4
  s_waitcnt vmcnt(0)
  s_waitcnt lgkmcnt(0)
  v_mov_b32 v6, 1
  s_mov_b64 exec, 1
  ds_add_u32 v1, v6 offset:104
  s_mov_b64 exec, -1
  s_mov_b32 s69, 0
Lpoll14:
  ds_read_b32 v6, v1 offset:104
  s_add_u32 s69, s69, 1
  s_cmp_gt_u32 s69, 0x100000
  s_cbranch_scc1 Lpoll14_x
  s_waitcnt lgkmcnt(0)
  v_readfirstlane_b32 s68, v6
  s_cmp_ge_u32 s68, 8
  s_cbranch_scc1 Lpoll14_x
  s_sleep 1
  s_branch Lpoll14
Lpoll14_x:
  s_waitcnt lgkmcnt(0)
  s_nop 0
  ds_read_b64_tr_b16 v[12:13], v8 offset:62848
  ds_read_b64_tr_b16 v[14:15], v8 offset:55424
  ds_read_b64_tr_b16 v[16:17], v8 offset:59136
  ds_read_b64_tr_b16 v[18:19], v8 offset:51712
  ds_read_b64_tr_b16 v[20:21], v8 offset:48000
  ds_read_b64_tr_b16 v[22:23], v8 offset:40576
  ds_read_b64_tr_b16 v[24:25], v8 offset:44288
  ds_read_b64_tr_b16 v[26:27], v8 offset:36864
  ds_read_b64_tr_b16 v[28:29], v8 offset:62912
  ds_read_b64_tr_b16 v[30:31], v8 offset:55488
  ds_read_b64_tr_b16 v[32:33], v8 offset:59200
  ds_read_b64_tr_b16 v[34:35], v8 offset:51776
  ds_read_b64_tr_b16 v[36:37], v8 offset:48064
  ds_read_b64_tr_b16 v[38:39], v8 offset:40640
  ds_read_b64_tr_b16 v[40:41], v8 offset:44352
  ds_read_b64_tr_b16 v[42:43], v8 offset:36928
  s_waitcnt lgkmcnt(8)
  s_nop 0
  v_mov_b32_dpp v44, v16 quad_perm:[1,0,3,2] row_mask:0xf bank_mask:0xf
  v_mov_b32_dpp v48, v12 quad_perm:[1,0,3,2] row_mask:0xf bank_mask:0xf
  v_mov_b32_dpp v45, v17 quad_perm:[1,0,3,2] row_mask:0xf bank_mask:0xf
  v_mov_b32_dpp v49, v13 quad_perm:[1,0,3,2] row_mask:0xf bank_mask:0xf
  v_mov_b32_dpp v46, v18 quad_perm:[1,0,3,2] row_mask:0xf bank_mask:0xf
  v_mov_b32_dpp v50, v14 quad_perm:[1,0,3,2] row_mask:0xf bank_mask:0xf
  v_mov_b32_dpp v47, v19 quad_perm:[1,0,3,2] row_mask:0xf bank_mask:0xf
  v_mov_b32_dpp v51, v15 quad_perm:[1,0,3,2] row_mask:0xf bank_mask:0xf
  v_cndmask_b32 v12, v12, v44, s[26:27]
  v_cndmask_b32 v16, v48, v16, s[26:27]
  v_cndmask_b32 v13, v13, v45, s[26:27]
  v_cndmask_b32 v17, v49, v17, s[26:27]
  v_cndmask_b32 v14, v14, v46, s[26:27]
  v_cndmask_b32 v18, v50, v18, s[26:27]
  v_cndmask_b32 v15, v15, v47, s[26:27]
  v_cndmask_b32 v19, v51, v19, s[26:27]
  v_mov_b32_dpp v44, v24 quad_perm:[1,0,3,2] row_mask:0xf bank_mask:0xf
  v_mov_b32_dpp v48, v20 quad_perm:[1,0,3,2] row_mask:0xf bank_mask:0xf
  v_mov_b32_dpp v45, v25 quad_perm:[1,0,3,2] row_mask:0xf bank_mask:0xf
  v_mov_b32_dpp v49, v21 quad_perm:[1,0,3,2] row_mask:0xf bank_mask:0xf
  v_mov_b32_dpp v46, v26 quad_perm:[1,0,3,2] row_mask:0xf bank_mask:0xf
  v_mov_b32_dpp v50, v22 quad_perm:[1,0,3,2] row_mask:0xf bank_mask:0xf
  v_mov_b32_dpp v47, v27 quad_perm:[1,0,3,2] row_mask:0xf bank_mask:0xf
  v_mov_b32_dpp v51, v23 quad_perm:[1,0,3,2] row_mask:0xf bank_mask:0xf
  v_cndmask_b32 v20, v20, v44, s[26:27]
  v_cndmask_b32 v24, v48, v24, s[26:27]
  v_cndmask_b32 v21, v21, v45, s[26:27]
  v_cndmask_b32 v25, v49, v25, s[26:27]
  v_cndmask_b32 v22, v22, v46, s[26:27]
  v_cndmask_b32 v26, v50, v26, s[26:27]
  v_cndmask_b32 v23, v23, v47, s[26:27]
  v_cndmask_b32 v27, v51, v27, s[26:27]
  v_mov_b32_dpp v44, v20 quad_perm:[2,3,0,1] row_mask:0xf bank_mask:0xf
  v_mov_b32_dpp v48, v12 quad_perm:[2,3,0,1] row_mask:0xf bank_mask:0xf
  v_mov_b32_dpp v45, v21 quad_perm:[2,3,0,1] row_mask:0xf bank_mask:0xf
  v_mov_b32_dpp v49, v13 quad_perm:[2,3,0,1] row_mask:0xf bank_mask:0xf
  v_mov_b32_dpp v46, v22 quad_perm:[2,3,0,1] row_mask:0xf bank_mask:0xf
  v_mov_b32_dpp v50, v14 quad_perm:[2,3,0,1] row_mask:0xf bank_mask:0xf
  v_mov_b32_dpp v47, v23 quad_perm:[2,3,0,1] row_mask:0xf bank_mask:0xf
  v_mov_b32_dpp v51, v15 quad_perm:[2,3,0,1] row_mask:0xf bank_mask:0xf
  v_cndmask_b32 v12, v12, v44, s[28:29]
  v_cndmask_b32 v20, v48, v20, s[28:29]
  v_cndmask_b32 v13, v13, v45, s[28:29]
  v_cndmask_b32 v21, v49, v21, s[28:29]
  v_cndmask_b32 v14, v14, v46, s[28:29]
  v_cndmask_b32 v22, v50, v22, s[28:29]
  v_cndmask_b32 v15, v15, v47, s[28:29]
  v_cndmask_b32 v23, v51, v23, s[28:29]
  v_mov_b32_dpp v44, v24 quad_perm:[2,3,0,1] row_mask:0xf bank_mask:0xf
  v_mov_b32_dpp v48, v16 quad_perm:[2,3,0,1] row_mask:0xf bank_mask:0xf
  v_mov_b32_dpp v45, v25 quad_perm:[2,3,0,1] row_mask:0xf bank_mask:0xf
  v_mov_b32_dpp v49, v17 quad_perm:[2,3,0,1] row_mask:0xf bank_mask:0xf
  v_mov_b32_dpp v46, v26 quad_perm:[2,3,0,1] row_mask:0xf bank_mask:0xf
  v_mov_b32_dpp v50, v18 quad_perm:[2,3,0,1] row_mask:0xf bank_mask:0xf
  v_mov_b32_dpp v47, v27 quad_perm:[2,3,0,1] row_mask:0xf bank_mask:0xf
  v_mov_b32_dpp v51, v19 quad_perm:[2,3,0,1] row_mask:0xf bank_mask:0xf
  v_cndmask_b32 v16, v16, v44, s[28:29]
  v_cndmask_b32 v24, v48, v24, s[28:29]
  v_cndmask_b32 v17, v17, v45, s[28:29]
  v_cndmask_b32 v25, v49, v25, s[28:29]
  v_cndmask_b32 v18, v18, v46, s[28:29]
  v_cndmask_b32 v26, v50, v26, s[28:29]
  v_cndmask_b32 v19, v19, v47, s[28:29]
  v_cndmask_b32 v27, v51, v27, s[28:29]
  s_add_u32 s61, s60, 0
  s_nop 0
  buffer_store_dwordx4 v[12:15], v9, s[12:15], s61 offen sc1
  s_add_u32 s61, s60, 4096
  buffer_store_dwordx4 v[16:19], v9, s[12:15], s61 offen sc1
  s_add_u32 s61, s60, 8192
  buffer_store_dwordx4 v[20:23], v9, s[12:15], s61 offen sc1
  s_add_u32 s61, s60, 12288
  buffer_store_dwordx4 v[24:27], v9, s[12:15], s61 offen sc1
  s_waitcnt lgkmcnt(0)
  s_nop 0
  v_mov_b32_dpp v44, v32 quad_perm:[1,0,3,2] row_mask:0xf bank_mask:0xf
  v_mov_b32_dpp v48, v28 quad_perm:[1,0,3,2] row_mask:0xf bank_mask:0xf
  v_mov_b32_dpp v45, v33 quad_perm:[1,0,3,2] row_mask:0xf bank_mask:0xf
  v_mov_b32_dpp v49, v29 quad_perm:[1,0,3,2] row_mask:0xf bank_mask:0xf
  v_mov_b32_dpp v46, v34 quad_perm:[1,0,3,2] row_mask:0xf bank_mask:0xf
  v_mov_b32_dpp v50, v30 quad_perm:[1,0,3,2] row_mask:0xf bank_mask:0xf
  v_mov_b32_dpp v47, v35 quad_perm:[1,0,3,2] row_mask:0xf bank_mask:0xf
  v_mov_b32_dpp v51, v31 quad_perm:[1,0,3,2] row_mask:0xf bank_mask:0xf
  v_cndmask_b32 v28, v28, v44, s[26:27]
  v_cndmask_b32 v32, v48, v32, s[26:27]
  v_cndmask_b32 v29, v29, v45, s[26:27]
  v_cndmask_b32 v33, v49, v33, s[26:27]
  v_cndmask_b32 v30, v30, v46, s[26:27]
  v_cndmask_b32 v34, v50, v34, s[26:27]
  v_cndmask_b32 v31, v31, v47, s[26:27]
  v_cndmask_b32 v35, v51, v35, s[26:27]
  v_mov_b32_dpp v44, v40 quad_perm:[1,0,3,2] row_mask:0xf bank_mask:0xf
  v_mov_b32_dpp v48, v36 quad_perm:[1,0,3,2] row_mask:0xf bank_mask:0xf
  v_mov_b32_dpp v45, v41 quad_perm:[1,0,3,2] row_mask:0xf bank_mask:0xf
  v_mov_b32_dpp v49, v37 quad_perm:[1,0,3,2] row_mask:0xf bank_mask:0xf
  v_mov_b32_dpp v46, v42 quad_perm:[1,0,3,2] row_mask:0xf bank_mask:0xf
  v_mov_b32_dpp v50, v38 quad_perm:[1,0,3,2] row_mask:0xf bank_mask:0xf
  v_mov_b32_dpp v47, v43 quad_perm:[1,0,3,2] row_mask:0xf bank_mask:0xf
  v_mov_b32_dpp v51, v39 quad_perm:[1,0,3,2] row_mask:0xf bank_mask:0xf
  v_cndmask_b32 v36, v36, v44, s[26:27]
  v_cndmask_b32 v40, v48, v40, s[26:27]
  v_cndmask_b32 v37, v37, v45, s[26:27]
  v_cndmask_b32 v41, v49, v41, s[26:27]
  v_cndmask_b32 v38, v38, v46, s[26:27]
  v_cndmask_b32 v42, v50, v42, s[26:27]
  v_cndmask_b32 v39, v39, v47, s[26:27]
  v_cndmask_b32 v43, v51, v43, s[26:27]
  v_mov_b32_dpp v44, v36 quad_perm:[2,3,0,1] row_mask:0xf bank_mask:0xf
  v_mov_b32_dpp v48, v28 quad_perm:[2,3,0,1] row_mask:0xf bank_mask:0xf
  v_mov_b32_dpp v45, v37 quad_perm:[2,3,0,1] row_mask:0xf bank_mask:0xf
  v_mov_b32_dpp v49, v29 quad_perm:[2,3,0,1] row_mask:0xf bank_mask:0xf
  v_mov_b32_dpp v46, v38 quad_perm:[2,3,0,1] row_mask:0xf bank_mask:0xf
  v_mov_b32_dpp v50, v30 quad_perm:[2,3,0,1] row_mask:0xf bank_mask:0xf
  v_mov_b32_dpp v47, v39 quad_perm:[2,3,0,1] row_mask:0xf bank_mask:0xf
  v_mov_b32_dpp v51, v31 quad_perm:[2,3,0,1] row_mask:0xf bank_mask:0xf
  v_cndmask_b32 v28, v28, v44, s[28:29]
  v_cndmask_b32 v36, v48, v36, s[28:29]
  v_cndmask_b32 v29, v29, v45, s[28:29]
  v_cndmask_b32 v37, v49, v37, s[28:29]
  v_cndmask_b32 v30, v30, v46, s[28:29]
  v_cndmask_b32 v38, v50, v38, s[28:29]
  v_cndmask_b32 v31, v31, v47, s[28:29]
  v_cndmask_b32 v39, v51, v39, s[28:29]
  v_mov_b32_dpp v44, v40 quad_perm:[2,3,0,1] row_mask:0xf bank_mask:0xf
  v_mov_b32_dpp v48, v32 quad_perm:[2,3,0,1] row_mask:0xf bank_mask:0xf
  v_mov_b32_dpp v45, v41 quad_perm:[2,3,0,1] row_mask:0xf bank_mask:0xf
  v_mov_b32_dpp v49, v33 quad_perm:[2,3,0,1] row_mask:0xf bank_mask:0xf
  v_mov_b32_dpp v46, v42 quad_perm:[2,3,0,1] row_mask:0xf bank_mask:0xf
  v_mov_b32_dpp v50, v34 quad_perm:[2,3,0,1] row_mask:0xf bank_mask:0xf
  v_mov_b32_dpp v47, v43 quad_perm:[2,3,0,1] row_mask:0xf bank_mask:0xf
  v_mov_b32_dpp v51, v35 quad_perm:[2,3,0,1] row_mask:0xf bank_mask:0xf
  v_cndmask_b32 v32, v32, v44, s[28:29]
  v_cndmask_b32 v40, v48, v40, s[28:29]
  v_cndmask_b32 v33, v33, v45, s[28:29]
  v_cndmask_b32 v41, v49, v41, s[28:29]
  v_cndmask_b32 v34, v34, v46, s[28:29]
  v_cndmask_b32 v42, v50, v42, s[28:29]
  v_cndmask_b32 v35, v35, v47, s[28:29]
  v_cndmask_b32 v43, v51, v43, s[28:29]
  s_add_u32 s61, s60, 131072
  buffer_store_dwordx4 v[28:31], v9, s[12:15], s61 offen sc1
  s_add_u32 s61, s60, 135168
  buffer_store_dwordx4 v[32:35], v9, s[12:15], s61 offen sc1
  s_add_u32 s61, s60, 139264
  buffer_store_dwordx4 v[36:39], v9, s[12:15], s61 offen sc1
  s_add_u32 s61, s60, 143360
  buffer_store_dwordx4 v[40:43], v9, s[12:15], s61 offen sc1
  s_branch L1_mend
L1_mi_wo:
  v_and_b32 v4, 1, v3
  v_lshrrev_b32 v5, 1, v3
  v_lshrrev_b32 v52, 2, v2
  v_mul_u32_u24 v52, 928, v52
  v_lshl_add_u32 v52, v4, 13, v52
  v_lshl_add_u32 v52, v5, 3, v52
  v_and_b32_e64 v6, 3, v2
  v_lshl_add_u32 v52, v6, 4, v52
  v_add_u32 v52, 98304, v52
  v_lshlrev_b32_e64 v53, 4, v2
  v_lshl_add_u32 v53, v4, 8, v53
  v_lshl_add_u32 v53, v5, 10, v53
  s_lshr_b32 s60, s24, 1
  s_lshl_b32 s60, s60, 12
  s_and_b32 s61, s24, 1
  s_lshl_b32 s61, s61, 9
  s_add_u32 s60, s60, s61
  s_add_u32 s60, s60, 0x200000
  s_waitcnt vmcnt(0)
  s_waitcnt lgkmcnt(0)
  v_mov_b32 v6, 1
  s_mov_b64 exec, 1
  ds_add_u32 v1, v6 offset:104
  s_mov_b64 exec, -1
  s_mov_b32 s69, 0
Lpoll15:
  ds_read_b32 v6, v1 offset:104
  s_add_u32 s69, s69, 1
  s_cmp_gt_u32 s69, 0x100000
  s_cbranch_scc1 Lpoll15_x
  s_waitcnt lgkmcnt(0)
  v_readfirstlane_b32 s68, v6
  s_cmp_ge_u32 s68, 8
  s_cbranch_scc1 Lpoll15_x
  s_sleep 1
  s_branch Lpoll15
Lpoll15_x:
  s_waitcnt lgkmcnt(0)
  ds_read_b64_tr_b16 v[56:57], v52 offset:0
  ds_read_b64_tr_b16 v[58:59], v52 offset:3712
  ds_read_b64_tr_b16 v[60:61], v52 offset:64
  ds_read_b64_tr_b16 v[62:63], v52 offset:3776
  ds_read_b64_tr_b16 v[64:65], v52 offset:128
  ds_read_b64_tr_b16 v[66:67], v52 offset:3840
  ds_read_b64_tr_b16 v[68:69], v52 offset:192
  ds_read_b64_tr_b16 v[70:71], v52 offset:3904
  ds_read_b64_tr_b16 v[72:73], v52 offset:256
  ds_read_b64_tr_b16 v[74:75], v52 offset:3968
  ds_read_b64_tr_b16 v[76:77], v52 offset:320
  ds_read_b64_tr_b16 v[78:79], v52 offset:4032
  ds_read_b64_tr_b16 v[80:81], v52 offset:384
  ds_read_b64_tr_b16 v[82:83], v52 offset:4096
  s_waitcnt lgkmcnt(0)
  v_and_b32 v59, 0xffff, v59
  s_add_u32 s61, s60, 0
  buffer_store_dwordx4 v[56:59], v53, s[12:15], s61 offen sc1
  v_and_b32 v63, 0xffff, v63
  s_add_u32 s61, s60, 2048
  buffer_store_dwordx4 v[60:63], v53, s[12:15], s61 offen sc1
  v_and_b32 v67, 0xffff, v67
  s_add_u32 s61, s60, 65536
  buffer_store_dwordx4 v[64:67], v53, s[12:15], s61 offen sc1
  v_and_b32 v71, 0xffff, v71
  s_add_u32 s61, s60, 67584
  buffer_store_dwordx4 v[68:71], v53, s[12:15], s61 offen sc1
  v_and_b32 v75, 0xffff, v75
  s_add_u32 s61, s60, 131072
  buffer_store_dwordx4 v[72:75], v53, s[12:15], s61 offen sc1
  v_and_b32 v79, 0xffff, v79
  s_add_u32 s61, s60, 133120
  buffer_store_dwordx4 v[76:79], v53, s[12:15], s61 offen sc1
  v_and_b32 v83, 0xffff, v83
  s_add_u32 s61, s60, 196608
  buffer_store_dwordx4 v[80:83], v53, s[12:15], s61 offen sc1
  ds_read_b64_tr_b16 v[84:85], v52 offset:448
  ds_read_b64_tr_b16 v[86:87], v52 offset:4160
  ds_read_b64_tr_b16 v[88:89], v52 offset:512
  ds_read_b64_tr_b16 v[90:91], v52 offset:4224
  ds_read_b64_tr_b16 v[92:93], v52 offset:576
  ds_read_b64_tr_b16 v[94:95], v52 offset:4288
  ds_read_b64_tr_b16 v[96:97], v52 offset:640
  ds_read_b64_tr_b16 v[98:99], v52 offset:4352
  ds_read_b64_tr_b16 v[100:101], v52 offset:704
  ds_read_b64_tr_b16 v[102:103], v52 offset:4416
  ds_read_b64_tr_b16 v[104:105], v52 offset:768
  ds_read_b64_tr_b16 v[106:107], v52 offset:4480
  ds_read_b64_tr_b16 v[108:109], v52 offset:832
  ds_read_b64_tr_b16 v[110:111], v52 offset:4544
  s_waitcnt lgkmcnt(0)
  s_nop 0
  v_and_b32 v87, 0xffff, v87
  s_add_u32 s61, s60, 198656
  buffer_store_dwordx4 v[84:87], v53, s[12:15], s61 offen sc1
  v_and_b32 v91, 0xffff, v91
  s_add_u32 s61, s60, 262144
  buffer_store_dwordx4 v[88:91], v53, s[12:15], s61 offen sc1
  v_and_b32 v95, 0xffff, v95
  s_add_u32 s61, s60, 264192
  buffer_store_dwordx4 v[92:95], v53, s[12:15], s61 offen sc1
  v_and_b32 v99, 0xffff, v99
  s_add_u32 s61, s60, 327680
  buffer_store_dwordx4 v[96:99], v53, s[12:15], s61 offen sc1
  v_and_b32 v103, 0xffff, v103
  s_add_u32 s61, s60, 329728
  buffer_store_dwordx4 v[100:103], v53, s[12:15], s61 offen sc1
  v_and_b32 v107, 0xffff, v107
  s_add_u32 s61, s60, 393216
  buffer_store_dwordx4 v[104:107], v53, s[12:15], s61 offen sc1
  v_and_b32 v111, 0xffff, v111
  s_add_u32 s61, s60, 395264
  buffer_store_dwordx4 v[108:111], v53, s[12:15], s61 offen sc1
L1_mend:
  s_endpgm
L1_end:
  s_endpgm
.globl p2_kernel
.type p2_kernel,@function
.p2align 8
p2_kernel:
  s_cmp_ge_u32 s2, 224
  s_cbranch_scc1 L2_end
  s_load_dwordx2 s[52:53], s[0:1], 80
  s_load_dwordx2 s[56:57], s[0:1], 96
  s_and_b32 s60, s2, 7
  s_lshr_b32 s61, s2, 3
  s_mul_i32 s20, s60, 28
  s_add_u32 s20, s20, s61
  v_lshrrev_b32 v1, 6, v0
  v_and_b32 v0, 63, v0
  v_readfirstlane_b32 s22, v1
  v_readfirstlane_b32 s3, v1
  v_mov_b32 v1, 119808
  v_mov_b32 v2, 0
  v_mov_b32_e64 v3, 0
  ds_write_b64 v1, v[2:3]
  s_waitcnt lgkmcnt(0)
  s_mov_b32 s12, s56
  s_mov_b32 s13, s57
  s_mov_b32 s14, 0x1000000
  s_mov_b32 s15, 0x20000
  s_mov_b32 s16, s52
  s_mov_b32 s17, s53
  s_mov_b32 s18, 0x380000
  s_mov_b32 s19, 0x20000
  s_cmp_ge_u32 s22, 4
  s_cbranch_scc1 L2_a2
  s_and_b32 s21, s20, 1
  s_lshr_b32 s23, s20, 1
  s_lshl_b32 s24, s23, 2
  s_add_u32 s24, s24, s22
  s_mul_i32 s25, s22, 17664
  v_lshlrev_b32 v2, 4, v0
  s_lshl_b32 s60, s24, 12
  s_nop 0
  s_add_u32 s60, s60, 0x280000
  buffer_load_dwordx4 v[4:7], v2, s[12:15], s60 offen offset:0
  buffer_load_dwordx4 v[8:11], v2, s[12:15], s60 offen offset:1024
  buffer_load_dwordx4 v[12:15], v2, s[12:15], s60 offen offset:2048
  buffer_load_dwordx4 v[16:19], v2, s[12:15], s60 offen offset:3072
  s_lshl_b32 s60, s24, 2
  s_nop 0
  s_add_u32 s60, s60, 0x610000
  s_load_dword s26, s[56:57], s60
  s_mul_i32 s60, s24, 4224
  s_add_u32 s60, s60, 0x440000
  s_add_u32 s61, s60, 4
  s_add_u32 m0, s25, 0
  s_nop 0
  s_nop 0
  buffer_load_dwordx4 v2, s[12:15], s60 offen offset:0 lds
  buffer_load_dwordx4 v2, s[12:15], s60 offen offset:1024 lds
  buffer_load_dwordx4 v2, s[12:15], s60 offen offset:2048 lds
  buffer_load_dwordx4 v2, s[12:15], s60 offen offset:3072 lds
  s_add_u32 m0, s25, 4224
  s_nop 0
  s_nop 0
  buffer_load_dwordx4 v2, s[12:15], s61 offen offset:0 lds
  buffer_load_dwordx4 v2, s[12:15], s61 offen offset:1024 lds
  buffer_load_dwordx4 v2, s[12:15], s61 offen offset:2048 lds
  buffer_load_dwordx4 v2, s[12:15], s61 offen offset:3072 lds
  s_mov_b64 exec, 15
  s_nop 0
  s_add_u32 m0, s25, 4096
  s_add_u32 s62, s60, 4096
  buffer_load_dwordx4 v2, s[12:15], s62 offen lds
  s_add_u32 m0, s25, 8320
  s_add_u32 s62, s61, 4096
  buffer_load_dwordx4 v2, s[12:15], s62 offen lds
  s_mov_b64 exec, -1
  s_barrier
  v_mov_b32 v24, 0
  v_mov_b32 v25, 0
  v_mov_b32 v26, 0
  v_mov_b32 v27, 0
  v_add_u32_e64 v28, s25, v2
  s_mov_b64 exec, 0x0fffffff
  ds_write_b128 v28, v[24:27] offset:12544
  ds_write_b128 v28, v[24:27] offset:17120
  s_mov_b64 exec, -1
  v_and_b32 v20, 15, v0
  v_lshrrev_b32 v21, 4, v0
  v_and_b32 v22, 1, v20
  v_cmp_eq_u32 s[60:61], 1, v22
  v_mov_b32 v22, 4224
  s_nop 0
  v_cndmask_b32 v22, v22, 4, s[60:61]
  v_lshl_add_u32 v22, v20, 2, v22
  v_lshl_add_u32 v22, v21, 4, v22
  v_add_u32 v29, s25, v22
  v_cmp_lt_u32 s[28:29], 7, v20
  v_mov_b32 v22, 13472
  v_mov_b32 v23, 8896
  v_cndmask_b32 v22, v22, v23, s[28:29]
  v_and_b32 v23, 7, v20
  v_lshlrev_b32 v23, 6, v23
  v_sub_u32_e64 v22, v22, v23
  v_lshl_add_u32 v22, v21, 4, v22
  v_add_u32 v30, s25, v22
  v_lshrrev_b32 v22, 3, v20
  v_lshl_add_u32 v22, v22, 3, v23
  v_lshl_add_u32 v22, v21, 4, v22
  v_add_u32_e64 v31, s25, v22
  v_mov_b32 v22, 0x05040100
  v_mov_b32 v23, 0x01000504
  v_cndmask_b32 v32, v22, v23, s[28:29]
  v_add_u32 v33, 0x02020202, v32
  s_waitcnt vmcnt(10)
  s_nop 0
  v_and_b32 v36, 0x7fff7fff, v4
  v_and_b32 v37, 0x7fff7fff, v5
  v_and_b32 v38, 0x7fff7fff, v6
  v_and_b32 v39, 0x7fff7fff, v7
  v_and_b32 v40, 0x7fff7fff, v8
  v_and_b32 v41, 0x7fff7fff, v9
  v_and_b32 v42, 0x7fff7fff, v10
  v_and_b32 v43, 0x7fff7fff, v11
  v_and_b32 v44, 0x7fff7fff, v12
  v_and_b32 v45, 0x7fff7fff, v13
  v_and_b32 v46, 0x7fff7fff, v14
  v_and_b32 v47, 0x7fff7fff, v15
  v_and_b32 v48, 0x7fff7fff, v16
  v_and_b32 v49, 0x7fff7fff, v17
  v_and_b32 v50, 0x7fff7fff, v18
  v_and_b32 v51, 0x7fff7fff, v19
  v_pk_max_u16 v22, v36, v37
  v_pk_max_u16 v23, v38, v39
  v_pk_max_u16 v23, v23, v40
  v_pk_max_u16 v22, v22, v41
  v_pk_max_u16 v23, v23, v42
  v_pk_max_u16 v22, v22, v43
  v_pk_max_u16 v23, v23, v44
  v_pk_max_u16 v22, v22, v45
  v_pk_max_u16 v23, v23, v46
  v_pk_max_u16 v22, v22, v47
  v_pk_max_u16 v23, v23, v48
  v_pk_max_u16 v22, v22, v49
  v_pk_max_u16 v23, v23, v50
  v_pk_max_u16 v22, v22, v51
  v_pk_max_u16 v22, v22, v23
  v_lshrrev_b32_e64 v23, 16, v22
  v_and_b32 v22, 0xffff, v22
  v_max_u32 v22, v22, v23
  s_nop 1
  v_max_u32_dpp v22, v22, v22 row_shr:1 row_mask:0xf bank_mask:0xf
  s_nop 1
  v_max_u32_dpp v22, v22, v22 row_shr:2 row_mask:0xf bank_mask:0xf
  s_nop 1
  v_max_u32_dpp v22, v22, v22 row_shr:4 row_mask:0xf bank_mask:0xf
  s_nop 1
  v_max_u32_dpp v22, v22, v22 row_shr:8 row_mask:0xf bank_mask:0xf
  s_nop 1
  v_max_u32_dpp v22, v22, v22 row_bcast:15 row_mask:0xa bank_mask:0xf
  s_nop 1
  v_max_u32_dpp v22, v22, v22 row_bcast:31 row_mask:0xc bank_mask:0xf
  s_nop 0
  v_readlane_b32 s60, v22, 63
  s_lshr_b32 s60, s60, 7
  s_max_u32 s60, s60, 30
  s_sub_u32 s61, s60, 14
  s_lshl_b32 s27, s61, 23
  s_sub_u32 s60, s60, 29
  s_lshl_b32 s60, s60, 7
  s_mul_i32 s60, s60, 0x10001
  s_mov_b32 s61, 0x80008000
  v_pk_sub_u16 v36, v36, s60 clamp
  v_pk_lshlrev_b16 v36, 3, v36 op_sel_hi:[0,1]
  v_and_or_b32 v36, v4, s61, v36
  v_pk_sub_u16 v37, v37, s60 clamp
  v_pk_lshlrev_b16 v37, 3, v37 op_sel_hi:[0,1]
  v_and_or_b32 v37, v5, s61, v37
  v_pk_sub_u16 v38, v38, s60 clamp
  v_pk_lshlrev_b16 v38, 3, v38 op_sel_hi:[0,1]
  v_and_or_b32 v38, v6, s61, v38
  v_pk_sub_u16 v39, v39, s60 clamp
  v_pk_lshlrev_b16 v39, 3, v39 op_sel_hi:[0,1]
  v_and_or_b32 v39, v7, s61, v39
  ds_write_b128 v28, v[36:39] offset:8448
  v_pk_sub_u16 v40, v40, s60 clamp
  v_pk_lshlrev_b16 v40, 3, v40 op_sel_hi:[0,1]
  v_and_or_b32 v40, v8, s61, v40
  v_pk_sub_u16 v41, v41, s60 clamp
  v_pk_lshlrev_b16 v41, 3, v41 op_sel_hi:[0,1]
  v_and_or_b32 v41, v9, s61, v41
  v_pk_sub_u16 v42, v42, s60 clamp
  v_pk_lshlrev_b16 v42, 3, v42 op_sel_hi:[0,1]
  v_and_or_b32 v42, v10, s61, v42
  v_pk_sub_u16 v43, v43, s60 clamp
  v_pk_lshlrev_b16 v43, 3, v43 op_sel_hi:[0,1]
  v_and_or_b32 v43, v11, s61, v43
  ds_write_b128 v28, v[40:43] offset:9472
  v_pk_sub_u16 v44, v44, s60 clamp
  v_pk_lshlrev_b16 v44, 3, v44 op_sel_hi:[0,1]
  v_and_or_b32 v44, v12, s61, v44
  v_pk_sub_u16 v45, v45, s60 clamp
  v_pk_lshlrev_b16 v45, 3, v45 op_sel_hi:[0,1]
  v_and_or_b32 v45, v13, s61, v45
  v_pk_sub_u16 v46, v46, s60 clamp
  v_pk_lshlrev_b16 v46, 3, v46 op_sel_hi:[0,1]
  v_and_or_b32 v46, v14, s61, v46
  v_pk_sub_u16 v47, v47, s60 clamp
  v_pk_lshlrev_b16 v47, 3, v47 op_sel_hi:[0,1]
  v_and_or_b32 v47, v15, s61, v47
  ds_write_b128 v28, v[44:47] offset:10496
  v_pk_sub_u16 v48, v48, s60 clamp
  v_pk_lshlrev_b16 v48, 3, v48 op_sel_hi:[0,1]
  v_and_or_b32 v48, v16, s61, v48
  v_pk_sub_u16 v49, v49, s60 clamp
  v_pk_lshlrev_b16 v49, 3, v49 op_sel_hi:[0,1]
  v_and_or_b32 v49, v17, s61, v49
  v_pk_sub_u16 v50, v50, s60 clamp
  v_pk_lshlrev_b16 v50, 3, v50 op_sel_hi:[0,1]
  v_and_or_b32 v50, v18, s61, v50
  v_pk_sub_u16 v51, v51, s60 clamp
  v_pk_lshlrev_b16 v51, 3, v51 op_sel_hi:[0,1]
  v_and_or_b32 v51, v19, s61, v51
  ds_write_b128 v28, v[48:51] offset:11520
  v_mov_b32_dpp v22, v36 wave_shl:1 row_mask:0xf bank_mask:0xf
  v_readlane_b32 s62, v40, 0
  s_nop 3
  s_nop 0
  v_writelane_b32 v22, s62, 63
  v_alignbit_b32 v4, v37, v36, 16
  v_alignbit_b32 v5, v38, v37, 16
  v_alignbit_b32 v6, v39, v38, 16
  v_alignbit_b32 v7, v22, v39, 16
  ds_write_b128 v28, v[4:7] offset:13024
  v_mov_b32_dpp v22, v40 wave_shl:1 row_mask:0xf bank_mask:0xf
  v_readlane_b32 s62, v44, 0
  s_nop 3
  s_nop 0
  v_writelane_b32 v22, s62, 63
  v_alignbit_b32 v8, v41, v40, 16
  v_alignbit_b32 v9, v42, v41, 16
  v_alignbit_b32 v10, v43, v42, 16
  v_alignbit_b32 v11, v22, v43, 16
  ds_write_b128 v28, v[8:11] offset:14048
  v_mov_b32_dpp v22, v44 wave_shl:1 row_mask:0xf bank_mask:0xf
  v_readlane_b32 s62, v48, 0
  s_nop 3
  s_nop 0
  v_writelane_b32 v22, s62, 63
  v_alignbit_b32 v12, v45, v44, 16
  v_alignbit_b32 v13, v46, v45, 16
  v_alignbit_b32 v14, v47, v46, 16
  v_alignbit_b32 v15, v22, v47, 16
  ds_write_b128 v28, v[12:15] offset:15072
  v_mov_b32_dpp v22, v48 wave_shl:1 row_mask:0xf bank_mask:0xf
  v_writelane_b32 v22, 0, 63
  v_alignbit_b32 v16, v49, v48, 16
  v_alignbit_b32 v17, v50, v49, 16
  v_alignbit_b32 v18, v51, v50, 16
  v_alignbit_b32 v19, v22, v51, 16
  ds_write_b128 v28, v[16:19] offset:16096
  v_mov_b32 v164, 0
  v_mov_b32 v165, 0
  v_mov_b32 v166, 0
  v_mov_b32 v167, 0
  v_mov_b32 v168, 0
  v_mov_b32 v169, 0
  v_mov_b32 v170, 0
  v_mov_b32 v171, 0
  v_mov_b32 v172, 0
  v_mov_b32 v173, 0
  v_mov_b32 v174, 0
  v_mov_b32 v175, 0
  v_mov_b32 v176, 0
  v_mov_b32 v177, 0
  v_mov_b32 v178, 0
  v_mov_b32 v179, 0
  s_waitcnt vmcnt(0) lgkmcnt(0)
  v_mov_b32 v22, s26
  v_mul_f32 v22, s27, v22
  v_mov_b32 v180, v22
  v_mov_b32 v181, v22
  s_cmp_eq_u32 s21, 0
  s_cbranch_scc0 L2_cvk1
  s_nop 0
  ds_read_b128 v[100:103], v30 offset:3584
  ds_read_b64 v[36:37], v29 offset:0
  ds_read_b64 v[38:39], v29 offset:8
  ds_read_b128 v[104:107], v30 offset:3072
  ds_read_b64 v[40:41], v29 offset:512
  ds_read_b64 v[42:43], v29 offset:520
  ds_read_b128 v[108:111], v30 offset:2560
  ds_read_b64 v[44:45], v29 offset:1024
  ds_read_b64 v[46:47], v29 offset:1032
  ds_read_b128 v[112:115], v30 offset:2048
  ds_read_b64 v[48:49], v29 offset:1536
  ds_read_b64 v[50:51], v29 offset:1544
  ds_read_b128 v[116:119], v30 offset:1536
  ds_read_b64 v[52:53], v29 offset:2048
  ds_read_b64 v[54:55], v29 offset:2056
  ds_read_b128 v[120:123], v30 offset:1024
  ds_read_b64 v[56:57], v29 offset:2560
  ds_read_b64 v[58:59], v29 offset:2568
  ds_read_b128 v[124:127], v30 offset:512
  ds_read_b64 v[60:61], v29 offset:3072
  ds_read_b64 v[62:63], v29 offset:3080
  ds_read_b128 v[128:131], v30 offset:0
  ds_read_b64 v[64:65], v29 offset:3584
  ds_read_b64 v[66:67], v29 offset:3592
  s_mov_b32 s60, 0
L2_cv0:
  s_waitcnt lgkmcnt(0)
  v_mfma_f32_16x16x32_f16 v[164:167], v[36:39], v[128:131], v[164:167]
  ds_read_b128 v[132:135], v30 offset:3648
  ds_read_b64 v[68:69], v29 offset:64
  v_mfma_f32_16x16x32_f16 v[168:171], v[36:39], v[116:119], v[168:171]
  ds_read_b64 v[70:71], v29 offset:72
  ds_read_b128 v[136:139], v30 offset:3136
  v_mfma_f32_16x16x32_f16 v[172:175], v[36:39], v[108:111], v[172:175]
  ds_read_b64 v[72:73], v29 offset:576
  v_mfma_f32_16x16x32_f16 v[176:179], v[36:39], v[104:107], v[176:179]
  ds_read_b64 v[74:75], v29 offset:584
  ds_read_b128 v[140:143], v30 offset:2624
  v_mfma_f32_16x16x32_f16 v[164:167], v[40:43], v[124:127], v[164:167]
  ds_read_b64 v[76:77], v29 offset:1088
  v_mfma_f32_16x16x32_f16 v[168:171], v[40:43], v[112:115], v[168:171]
  ds_read_b64 v[78:79], v29 offset:1096
  ds_read_b128 v[144:147], v30 offset:2112
  v_mfma_f32_16x16x32_f16 v[172:175], v[40:43], v[104:107], v[172:175]
  ds_read_b64 v[80:81], v29 offset:1600
  ds_read_b64 v[82:83], v29 offset:1608
  v_mfma_f32_16x16x32_f16 v[176:179], v[40:43], v[100:103], v[176:179]
  ds_read_b128 v[148:151], v30 offset:1600
  v_mfma_f32_16x16x32_f16 v[164:167], v[44:47], v[120:123], v[164:167]
  ds_read_b64 v[84:85], v29 offset:2112
  ds_read_b64 v[86:87], v29 offset:2120
  v_mfma_f32_16x16x32_f16 v[168:171], v[44:47], v[108:111], v[168:171]
  ds_read_b128 v[152:155], v30 offset:1088
  v_mfma_f32_16x16x32_f16 v[172:175], v[44:47], v[100:103], v[172:175]
  ds_read_b64 v[88:89], v29 offset:2624
  ds_read_b64 v[90:91], v29 offset:2632
  v_mfma_f32_16x16x32_f16 v[164:167], v[48:51], v[116:119], v[164:167]
  ds_read_b128 v[156:159], v30 offset:576
  ds_read_b64 v[92:93], v29 offset:3136
  v_mfma_f32_16x16x32_f16 v[168:171], v[48:51], v[104:107], v[168:171]
  ds_read_b64 v[94:95], v29 offset:3144
  v_mfma_f32_16x16x32_f16 v[164:167], v[52:55], v[112:115], v[164:167]
  ds_read_b128 v[160:163], v30 offset:64
  ds_read_b64 v[96:97], v29 offset:3648
  v_mfma_f32_16x16x32_f16 v[168:171], v[52:55], v[100:103], v[168:171]
  ds_read_b64 v[98:99], v29 offset:3656
  v_mfma_f32_16x16x32_f16 v[164:167], v[56:59], v[108:111], v[164:167]
  v_mfma_f32_16x16x32_f16 v[164:167], v[60:63], v[104:107], v[164:167]
  v_mfma_f32_16x16x32_f16 v[164:167], v[64:67], v[100:103], v[164:167]
  s_waitcnt lgkmcnt(0)
  s_nop 0
  v_mfma_f32_16x16x32_f16 v[164:167], v[68:71], v[160:163], v[164:167]
  ds_read_b128 v[100:103], v30 offset:3712
  ds_read_b64 v[36:37], v29 offset:128
  v_mfma_f32_16x16x32_f16 v[168:171], v[68:71], v[148:151], v[168:171]
  ds_read_b64 v[38:39], v29 offset:136
  ds_read_b128 v[104:107], v30 offset:3200
  v_mfma_f32_16x16x32_f16 v[172:175], v[68:71], v[140:143], v[172:175]
  ds_read_b64 v[40:41], v29 offset:640
  v_mfma_f32_16x16x32_f16 v[176:179], v[68:71], v[136:139], v[176:179]
  ds_read_b64 v[42:43], v29 offset:648
  ds_read_b128 v[108:111], v30 offset:2688
  v_mfma_f32_16x16x32_f16 v[164:167], v[72:75], v[156:159], v[164:167]
  ds_read_b64 v[44:45], v29 offset:1152
  v_mfma_f32_16x16x32_f16 v[168:171], v[72:75], v[144:147], v[168:171]
  ds_read_b64 v[46:47], v29 offset:1160
  ds_read_b128 v[112:115], v30 offset:2176
  v_mfma_f32_16x16x32_f16 v[172:175], v[72:75], v[136:139], v[172:175]
  ds_read_b64 v[48:49], v29 offset:1664
  ds_read_b64 v[50:51], v29 offset:1672
  v_mfma_f32_16x16x32_f16 v[176:179], v[72:75], v[132:135], v[176:179]
  ds_read_b128 v[116:119], v30 offset:1664
  v_mfma_f32_16x16x32_f16 v[164:167], v[76:79], v[152:155], v[164:167]
  ds_read_b64 v[52:53], v29 offset:2176
  ds_read_b64 v[54:55], v29 offset:2184
  v_mfma_f32_16x16x32_f16 v[168:171], v[76:79], v[140:143], v[168:171]
  ds_read_b128 v[120:123], v30 offset:1152
  v_mfma_f32_16x16x32_f16 v[172:175], v[76:79], v[132:135], v[172:175]
  ds_read_b64 v[56:57], v29 offset:2688
  ds_read_b64 v[58:59], v29 offset:2696
  v_mfma_f32_16x16x32_f16 v[164:167], v[80:83], v[148:151], v[164:167]
  ds_read_b128 v[124:127], v30 offset:640
  ds_read_b64 v[60:61], v29 offset:3200
  v_mfma_f32_16x16x32_f16 v[168:171], v[80:83], v[136:139], v[168:171]
  ds_read_b64 v[62:63], v29 offset:3208
  v_mfma_f32_16x16x32_f16 v[164:167], v[84:87], v[144:147], v[164:167]
  ds_read_b128 v[128:131], v30 offset:128
  ds_read_b64 v[64:65], v29 offset:3712
  v_mfma_f32_16x16x32_f16 v[168:171], v[84:87], v[132:135], v[168:171]
  ds_read_b64 v[66:67], v29 offset:3720
  v_mfma_f32_16x16x32_f16 v[164:167], v[88:91], v[140:143], v[164:167]
  v_mfma_f32_16x16x32_f16 v[164:167], v[92:95], v[136:139], v[164:167]
  v_mfma_f32_16x16x32_f16 v[164:167], v[96:99], v[132:135], v[164:167]
  v_add_u32 v29, 0x80, v29
  v_add_u32 v30, 0x80, v30
  s_add_u32 s60, s60, 1
  s_cmp_lt_u32 s60, 4
  s_cbranch_scc1 L2_cv0
  s_branch L2_cvdone
L2_cvk1:
  ds_read_b128 v[100:103], v30 offset:3584
  ds_read_b64 v[36:37], v29 offset:0
  ds_read_b64 v[38:39], v29 offset:8
  ds_read_b128 v[104:107], v30 offset:3072
  ds_read_b64 v[40:41], v29 offset:512
  ds_read_b64 v[42:43], v29 offset:520
  ds_read_b128 v[108:111], v30 offset:2560
  ds_read_b64 v[44:45], v29 offset:1024
  ds_read_b64 v[46:47], v29 offset:1032
  ds_read_b128 v[112:115], v30 offset:2048
  ds_read_b64 v[48:49], v29 offset:1536
  ds_read_b64 v[50:51], v29 offset:1544
  ds_read_b128 v[116:119], v30 offset:1536
  ds_read_b64 v[52:53], v29 offset:2048
  ds_read_b64 v[54:55], v29 offset:2056
  ds_read_b128 v[120:123], v30 offset:1024
  ds_read_b64 v[56:57], v29 offset:2560
  ds_read_b64 v[58:59], v29 offset:2568
  ds_read_b128 v[124:127], v30 offset:512
  ds_read_b64 v[60:61], v29 offset:3072
  ds_read_b64 v[62:63], v29 offset:3080
  s_mov_b32 s60, 0
L2_cv1:
  s_waitcnt lgkmcnt(0)
  v_mfma_f32_16x16x32_f16 v[164:167], v[36:39], v[124:127], v[164:167]
  ds_read_b128 v[132:135], v30 offset:3648
  ds_read_b64 v[68:69], v29 offset:64
  v_mfma_f32_16x16x32_f16 v[168:171], v[36:39], v[120:123], v[168:171]
  ds_read_b64 v[70:71], v29 offset:72
  v_mfma_f32_16x16x32_f16 v[172:175], v[36:39], v[112:115], v[172:175]
  ds_read_b128 v[136:139], v30 offset:3136
  ds_read_b64 v[72:73], v29 offset:576
  v_mfma_f32_16x16x32_f16 v[176:179], v[36:39], v[100:103], v[176:179]
  ds_read_b64 v[74:75], v29 offset:584
  v_mfma_f32_16x16x32_f16 v[164:167], v[40:43], v[120:123], v[164:167]
  ds_read_b128 v[140:143], v30 offset:2624
  v_mfma_f32_16x16x32_f16 v[168:171], v[40:43], v[116:119], v[168:171]
  ds_read_b64 v[76:77], v29 offset:1088
  ds_read_b64 v[78:79], v29 offset:1096
  v_mfma_f32_16x16x32_f16 v[172:175], v[40:43], v[108:111], v[172:175]
  ds_read_b128 v[144:147], v30 offset:2112
  v_mfma_f32_16x16x32_f16 v[164:167], v[44:47], v[116:119], v[164:167]
  ds_read_b64 v[80:81], v29 offset:1600
  ds_read_b64 v[82:83], v29 offset:1608
  v_mfma_f32_16x16x32_f16 v[168:171], v[44:47], v[112:115], v[168:171]
  ds_read_b128 v[148:151], v30 offset:1600
  v_mfma_f32_16x16x32_f16 v[172:175], v[44:47], v[104:107], v[172:175]
  ds_read_b64 v[84:85], v29 offset:2112
  v_mfma_f32_16x16x32_f16 v[164:167], v[48:51], v[112:115], v[164:167]
  ds_read_b64 v[86:87], v29 offset:2120
  ds_read_b128 v[152:155], v30 offset:1088
  v_mfma_f32_16x16x32_f16 v[168:171], v[48:51], v[108:111], v[168:171]
  ds_read_b64 v[88:89], v29 offset:2624
  v_mfma_f32_16x16x32_f16 v[172:175], v[48:51], v[100:103], v[172:175]
  ds_read_b64 v[90:91], v29 offset:2632
  ds_read_b128 v[156:159], v30 offset:576
  v_mfma_f32_16x16x32_f16 v[164:167], v[52:55], v[108:111], v[164:167]
  ds_read_b64 v[92:93], v29 offset:3136
  v_mfma_f32_16x16x32_f16 v[168:171], v[52:55], v[104:107], v[168:171]
  ds_read_b64 v[94:95], v29 offset:3144
  v_mfma_f32_16x16x32_f16 v[164:167], v[56:59], v[104:107], v[164:167]
  v_mfma_f32_16x16x32_f16 v[168:171], v[56:59], v[100:103], v[168:171]
  v_mfma_f32_16x16x32_f16 v[164:167], v[60:63], v[100:103], v[164:167]
  s_waitcnt lgkmcnt(0)
  s_nop 0
  v_mfma_f32_16x16x32_f16 v[164:167], v[68:71], v[156:159], v[164:167]
  ds_read_b128 v[100:103], v30 offset:3712
  ds_read_b64 v[36:37], v29 offset:128
  v_mfma_f32_16x16x32_f16 v[168:171], v[68:71], v[152:155], v[168:171]
  ds_read_b64 v[38:39], v29 offset:136
  v_mfma_f32_16x16x32_f16 v[172:175], v[68:71], v[144:147], v[172:175]
  ds_read_b128 v[104:107], v30 offset:3200
  ds_read_b64 v[40:41], v29 offset:640
  v_mfma_f32_16x16x32_f16 v[176:179], v[68:71], v[132:135], v[176:179]
  ds_read_b64 v[42:43], v29 offset:648
  v_mfma_f32_16x16x32_f16 v[164:167], v[72:75], v[152:155], v[164:167]
  ds_read_b128 v[108:111], v30 offset:2688
  v_mfma_f32_16x16x32_f16 v[168:171], v[72:75], v[148:151], v[168:171]
  ds_read_b64 v[44:45], v29 offset:1152
  ds_read_b64 v[46:47], v29 offset:1160
  v_mfma_f32_16x16x32_f16 v[172:175], v[72:75], v[140:143], v[172:175]
  ds_read_b128 v[112:115], v30 offset:2176
  v_mfma_f32_16x16x32_f16 v[164:167], v[76:79], v[148:151], v[164:167]
  ds_read_b64 v[48:49], v29 offset:1664
  ds_read_b64 v[50:51], v29 offset:1672
  v_mfma_f32_16x16x32_f16 v[168:171], v[76:79], v[144:147], v[168:171]
  ds_read_b128 v[116:119], v30 offset:1664
  v_mfma_f32_16x16x32_f16 v[172:175], v[76:79], v[136:139], v[172:175]
  ds_read_b64 v[52:53], v29 offset:2176
  v_mfma_f32_16x16x32_f16 v[164:167], v[80:83], v[144:147], v[164:167]
  ds_read_b64 v[54:55], v29 offset:2184
  ds_read_b128 v[120:123], v30 offset:1152
  v_mfma_f32_16x16x32_f16 v[168:171], v[80:83], v[140:143], v[168:171]
  ds_read_b64 v[56:57], v29 offset:2688
  v_mfma_f32_16x16x32_f16 v[172:175], v[80:83], v[132:135], v[172:175]
  ds_read_b64 v[58:59], v29 offset:2696
  ds_read_b128 v[124:127], v30 offset:640
  v_mfma_f32_16x16x32_f16 v[164:167], v[84:87], v[140:143], v[164:167]
  ds_read_b64 v[60:61], v29 offset:3200
  v_mfma_f32_16x16x32_f16 v[168:171], v[84:87], v[136:139], v[168:171]
  ds_read_b64 v[62:63], v29 offset:3208
  v_mfma_f32_16x16x32_f16 v[164:167], v[88:91], v[136:139], v[164:167]
  v_mfma_f32_16x16x32_f16 v[168:171], v[88:91], v[132:135], v[168:171]
  v_mfma_f32_16x16x32_f16 v[164:167], v[92:95], v[132:135], v[164:167]
  v_add_u32 v29, 0x80, v29
  v_add_u32 v30, 0x80, v30
  s_add_u32 s60, s60, 1
  s_cmp_lt_u32 s60, 4
  s_cbranch_scc1 L2_cv1
L2_cvdone:
  s_waitcnt lgkmcnt(0)
  s_nop 1
  s_nop 0
  v_pk_mul_f32 v[164:165], v[164:165], v[180:181]
  v_pk_mul_f32 v[166:167], v[166:167], v[180:181]
  v_cvt_pk_bf16_f32 v36, v164, v165
  v_cvt_pk_bf16_f32 v37, v166, v167
  v_cndmask_b32 v38, v37, v36, s[28:29]
  v_cndmask_b32 v39, v36, v37, s[28:29]
  v_pk_mul_f32 v[168:169], v[168:169], v[180:181]
  v_pk_mul_f32 v[170:171], v[170:171], v[180:181]
  v_cvt_pk_bf16_f32 v40, v168, v169
  v_cvt_pk_bf16_f32 v41, v170, v171
  v_cndmask_b32 v42, v41, v40, s[28:29]
  v_cndmask_b32 v43, v40, v41, s[28:29]
  v_pk_mul_f32 v[172:173], v[172:173], v[180:181]
  v_pk_mul_f32 v[174:175], v[174:175], v[180:181]
  v_cvt_pk_bf16_f32 v44, v172, v173
  v_cvt_pk_bf16_f32 v45, v174, v175
  v_cndmask_b32 v46, v45, v44, s[28:29]
  v_cndmask_b32 v47, v44, v45, s[28:29]
  v_pk_mul_f32 v[176:177], v[176:177], v[180:181]
  v_pk_mul_f32 v[178:179], v[178:179], v[180:181]
  v_cvt_pk_bf16_f32 v48, v176, v177
  v_cvt_pk_bf16_f32 v49, v178, v179
  v_cndmask_b32 v50, v49, v48, s[28:29]
  v_cndmask_b32 v51, v48, v49, s[28:29]
  v_mov_b32_dpp v54, v38 row_ror:8 row_mask:0xf bank_mask:0xf
  v_perm_b32 v52, v54, v39, v32
  v_perm_b32 v53, v54, v39, v33
  ds_write_b64 v31, v[52:53] offset:0
  v_mov_b32_dpp v58, v42 row_ror:8 row_mask:0xf bank_mask:0xf
  v_perm_b32 v56, v58, v43, v32
  v_perm_b32 v57, v58, v43, v33
  ds_write_b64 v31, v[56:57] offset:512
  v_mov_b32_dpp v62, v46 row_ror:8 row_mask:0xf bank_mask:0xf
  v_perm_b32 v60, v62, v47, v32
  v_perm_b32 v61, v62, v47, v33
  ds_write_b64 v31, v[60:61] offset:1024
  v_mov_b32_dpp v66, v50 row_ror:8 row_mask:0xf bank_mask:0xf
  v_perm_b32 v64, v66, v51, v32
  v_perm_b32 v65, v66, v51, v33
  ds_write_b64 v31, v[64:65] offset:1536
  s_waitcnt lgkmcnt(0)
  v_mov_b32 v22, 1
  s_mov_b64 s[68:69], exec
  s_mov_b64 exec, 1
  ds_add_u32 v1, v22 offset:0
  s_mov_b64 exec, s[68:69]
  s_mov_b32 s69, 0
L2_cvsync:
  ds_read_b32 v22, v1 offset:0
  s_add_u32 s69, s69, 1
  s_cmp_gt_u32 s69, 0x100000
  s_cbranch_scc1 L2_cvsync_x
  s_waitcnt lgkmcnt(0)
  v_readfirstlane_b32 s68, v22
  s_cmp_lt_u32 s68, 4
  s_cbranch_scc1 L2_cvsync
L2_cvsync_x:
  s_lshl_b32 s60, s22, 9
  s_nop 0
  v_lshl_add_u32 v22, v0, 3, s60
  ds_read_b64 v[100:101], v22 offset:0
  ds_read_b64 v[104:105], v22 offset:17664
  ds_read_b64 v[108:109], v22 offset:35328
  ds_read_b64 v[112:113], v22 offset:52992
  s_lshl_b32 s60, s21, 2
  s_add_u32 s60, s60, s22
  s_lshl_b32 s60, s60, 2
  s_lshr_b32 s60, 0x3561247, s60
  s_and_b32 s60, s60, 7
  s_mul_i32 s60, s60, 458752
  s_lshl_b32 s61, s23, 3
  s_add_u32 s60, s60, s61
  s_add_u32 s60, s60, 896
  v_mul_u32_u24 v23, 7168, v0
  s_mov_b32 s62, 0x05040100
  s_mov_b32 s63, 0x07060302
  s_waitcnt lgkmcnt(0)
  s_nop 0
  v_perm_b32 v132, v104, v100, s62
  v_perm_b32 v133, v112, v108, s62
  buffer_store_dwordx2 v[132:133], v23, s[16:19], s60 offen offset:0
  v_perm_b32 v136, v104, v100, s63
  v_perm_b32 v137, v112, v108, s63
  buffer_store_dwordx2 v[136:137], v23, s[16:19], s60 offen offset:1792
  v_perm_b32 v140, v105, v101, s62
  v_perm_b32 v141, v113, v109, s62
  s_add_u32 s60, s60, 3584
  buffer_store_dwordx2 v[140:141], v23, s[16:19], s60 offen offset:0
  v_perm_b32 v144, v105, v101, s63
  v_perm_b32 v145, v113, v109, s63
  buffer_store_dwordx2 v[144:145], v23, s[16:19], s60 offen offset:1792
  s_endpgm
L2_a2:
  s_sub_u32 s22, s22, 4
  s_mul_i32 s60, s20, 9363
  s_lshr_b32 s21, s60, 16
  s_mul_i32 s60, s21, 7
  s_sub_u32 s23, s20, s60
  v_lshlrev_b32 v8, 4, v0
  v_and_b32 v2, 15, v0
  v_lshrrev_b32 v3, 4, v0
  v_lshlrev_b32 v6, 2, v0
  v_and_b32 v4, 3, v0
  v_cmp_eq_u32 s[60:61], 3, v4
  v_lshlrev_b32 v5, 6, v3
  v_add_u32 v5, 12, v5
  v_cndmask_b32 v7, v6, v5, s[60:61]
  s_lshl_b32 s30, s22, 13
  s_add_u32 s30, s30, 120064
  v_add_u32 v6, s30, v6
  v_add_u32 v7, s30, v7
  s_add_u32 s60, s22, 0
  s_and_b32 s60, s60, 3
  s_lshl_b32 s61, s21, 2
  s_add_u32 s60, s60, s61
  s_lshl_b32 s60, s60, 14
  s_lshl_b32 s61, s22, 12
  s_add_u32 s24, s60, s61
  s_add_u32 s60, s22, 1
  s_and_b32 s60, s60, 3
  s_lshl_b32 s61, s21, 2
  s_add_u32 s60, s60, s61
  s_lshl_b32 s60, s60, 14
  s_lshl_b32 s61, s22, 12
  s_add_u32 s25, s60, s61
  s_add_u32 s60, s22, 2
  s_and_b32 s60, s60, 3
  s_lshl_b32 s61, s21, 2
  s_add_u32 s60, s60, s61
  s_lshl_b32 s60, s60, 14
  s_lshl_b32 s61, s22, 12
  s_add_u32 s26, s60, s61
  s_add_u32 s60, s22, 3
  s_and_b32 s60, s60, 3
  s_lshl_b32 s61, s21, 2
  s_add_u32 s60, s60, s61
  s_lshl_b32 s60, s60, 14
  s_lshl_b32 s61, s22, 12
  s_add_u32 s27, s60, s61
  s_lshl_b32 s28, s23, 16
  s_lshl_b32 s61, s22, 14
  s_add_u32 s28, s28, s61
  s_add_u32 s28, s28, 0x200000
  s_lshl_b32 s29, s22, 14
  s_add_u32 s29, s29, 0x620000
  v_cmp_gt_u32 s[60:61], 3, v3
  s_nop 1
  v_cndmask_b32 v9, 0, -1, s[60:61]
  s_barrier
  s_add_u32 m0, s30, 0
  s_nop 0
  s_nop 0
  buffer_load_dwordx4 v8, s[12:15], s29 offen offset:0 lds
  buffer_load_dwordx4 v8, s[12:15], s29 offen offset:1024 lds
  buffer_load_dwordx4 v8, s[12:15], s29 offen offset:2048 lds
  buffer_load_dwordx4 v8, s[12:15], s29 offen offset:3072 lds
  s_add_u32 s29, s29, 4096
  buffer_load_dwordx4 v[92:95], v8, s[12:15], s24 offen offset:0
  buffer_load_dwordx4 v[96:99], v8, s[12:15], s25 offen offset:0
  buffer_load_dwordx4 v[100:103], v8, s[12:15], s26 offen offset:0
  buffer_load_dwordx4 v[104:107], v8, s[12:15], s27 offen offset:0
  buffer_load_dwordx4 v[140:143], v8, s[12:15], s28 offen offset:0
  buffer_load_dwordx4 v[144:147], v8, s[12:15], s28 offen offset:1024
  buffer_load_dwordx4 v[148:151], v8, s[12:15], s28 offen offset:2048
  buffer_load_dwordx4 v[152:155], v8, s[12:15], s28 offen offset:3072
  s_add_u32 s28, s28, 4096
  s_add_u32 m0, s30, 4096
  s_nop 0
  s_nop 0
  buffer_load_dwordx4 v8, s[12:15], s29 offen offset:0 lds
  buffer_load_dwordx4 v8, s[12:15], s29 offen offset:1024 lds
  buffer_load_dwordx4 v8, s[12:15], s29 offen offset:2048 lds
  buffer_load_dwordx4 v8, s[12:15], s29 offen offset:3072 lds
  s_add_u32 s29, s29, 4096
  buffer_load_dwordx4 v[108:111], v8, s[12:15], s24 offen offset:1024
  buffer_load_dwordx4 v[112:115], v8, s[12:15], s25 offen offset:1024
  buffer_load_dwordx4 v[116:119], v8, s[12:15], s26 offen offset:1024
  buffer_load_dwordx4 v[120:123], v8, s[12:15], s27 offen offset:1024
  buffer_load_dwordx4 v[156:159], v8, s[12:15], s28 offen offset:0
  buffer_load_dwordx4 v[160:163], v8, s[12:15], s28 offen offset:1024
  buffer_load_dwordx4 v[164:167], v8, s[12:15], s28 offen offset:2048
  buffer_load_dwordx4 v[168:171], v8, s[12:15], s28 offen offset:3072
  s_add_u32 s28, s28, 4096
  s_waitcnt vmcnt(20)
  s_nop 0
  ds_read2st64_b32 v[76:77], v6 offset0:0 offset1:1
  ds_read2st64_b32 v[78:79], v6 offset0:2 offset1:3
  ds_read2st64_b32 v[80:81], v6 offset0:4 offset1:5
  ds_read2st64_b32 v[82:83], v6 offset0:6 offset1:7
  ds_read2st64_b32 v[84:85], v7 offset0:8 offset1:9
  ds_read2st64_b32 v[86:87], v7 offset0:10 offset1:11
  ds_read2st64_b32 v[88:89], v7 offset0:12 offset1:13
  ds_read2st64_b32 v[90:91], v7 offset0:14 offset1:15
  s_waitcnt lgkmcnt(0)
  s_nop 0
  v_cvt_pk_bf16_f32 v188, v76, v77
  v_cvt_pk_bf16_f32 v189, v78, v79
  v_cvt_pk_bf16_f32 v190, v80, v81
  v_cvt_pk_bf16_f32 v191, v82, v83
  v_cvt_pk_bf16_f32 v192, v84, v85
  v_cvt_pk_bf16_f32 v193, v86, v87
  v_cvt_pk_bf16_f32 v194, v88, v89
  v_cvt_pk_bf16_f32 v195, v90, v91
  s_add_u32 m0, s30, 0
  s_nop 0
  buffer_load_dwordx4 v8, s[12:15], s29 offen offset:0 lds
  buffer_load_dwordx4 v8, s[12:15], s29 offen offset:1024 lds
  buffer_load_dwordx4 v8, s[12:15], s29 offen offset:2048 lds
  buffer_load_dwordx4 v8, s[12:15], s29 offen offset:3072 lds
  s_add_u32 s29, s29, 4096
  buffer_load_dwordx4 v[124:127], v8, s[12:15], s24 offen offset:2048
  buffer_load_dwordx4 v[128:131], v8, s[12:15], s25 offen offset:2048
  buffer_load_dwordx4 v[132:135], v8, s[12:15], s26 offen offset:2048
  buffer_load_dwordx4 v[136:139], v8, s[12:15], s27 offen offset:2048
  s_waitcnt vmcnt(24)
  v_and_b32 v94, v9, v94
  v_and_b32 v95, v9, v95
  v_and_b32 v98, v9, v98
  v_and_b32 v99, v9, v99
  v_and_b32 v102, v9, v102
  v_and_b32 v103, v9, v103
  v_and_b32 v106, v9, v106
  v_and_b32_e64 v107, v9, v107
  v_mfma_f32_16x16x32_bf16 v[200:203], v[192:195], v[92:95], 0
  v_mfma_f32_16x16x32_bf16 v[196:199], v[188:191], v[92:95], 0
  v_mfma_f32_16x16x32_bf16 v[208:211], v[192:195], v[96:99], 0
  v_mfma_f32_16x16x32_bf16 v[204:207], v[188:191], v[96:99], 0
  v_mfma_f32_16x16x32_bf16 v[216:219], v[192:195], v[100:103], 0
  v_mfma_f32_16x16x32_bf16 v[212:215], v[188:191], v[100:103], 0
  v_mfma_f32_16x16x32_bf16 v[224:227], v[192:195], v[104:107], 0
  v_mfma_f32_16x16x32_bf16 v[220:223], v[188:191], v[104:107], 0
  buffer_load_dwordx4 v[172:175], v8, s[12:15], s28 offen offset:0
  buffer_load_dwordx4 v[176:179], v8, s[12:15], s28 offen offset:1024
  buffer_load_dwordx4 v[180:183], v8, s[12:15], s28 offen offset:2048
  buffer_load_dwordx4 v[184:187], v8, s[12:15], s28 offen offset:3072
  s_add_u32 s28, s28, 4096
  v_add_f32 v228, 0x358637bd, v203
  v_add_f32 v230, 0x358637bd, v211
  v_add_f32 v232, 0x358637bd, v219
  v_add_f32 v234, 0x358637bd, v227
  v_rcp_f32 v228, v228
  v_rcp_f32 v230, v230
  v_rcp_f32 v232, v232
  v_rcp_f32 v234, v234
  s_waitcnt vmcnt(24)
  v_mul_f32 v196, v196, v228
  v_mul_f32 v197, v197, v228
  v_mul_f32 v198, v198, v228
  v_mul_f32 v199, v199, v228
  v_mul_f32 v200, v200, v228
  v_mul_f32 v201, v201, v228
  v_mul_f32 v202, v202, v228
  v_cvt_pk_bf16_f32 v92, v196, v197
  v_cvt_pk_bf16_f32 v93, v198, v199
  v_cvt_pk_bf16_f32 v94, v200, v201
  v_cvt_pk_bf16_f32 v95, v202, 0
  v_mul_f32 v204, v204, v230
  v_mul_f32 v205, v205, v230
  v_mul_f32 v206, v206, v230
  v_mul_f32 v207, v207, v230
  v_mul_f32 v208, v208, v230
  v_mul_f32 v209, v209, v230
  v_mul_f32_e64 v210, v210, v230
  v_cvt_pk_bf16_f32 v96, v204, v205
  v_cvt_pk_bf16_f32 v97, v206, v207
  v_cvt_pk_bf16_f32 v98, v208, v209
  v_cvt_pk_bf16_f32 v99, v210, 0
  v_mfma_f32_16x16x32_bf16 v[12:15], v[140:143], v[92:95], 0
  v_mfma_f32_16x16x32_bf16 v[28:31], v[144:147], v[92:95], 0
  v_mfma_f32_16x16x32_bf16 v[44:47], v[148:151], v[92:95], 0
  v_mfma_f32_16x16x32_bf16 v[60:63], v[152:155], v[92:95], 0
  v_mul_f32 v212, v212, v232
  v_mul_f32 v213, v213, v232
  v_mul_f32 v214, v214, v232
  v_mul_f32 v215, v215, v232
  v_mul_f32 v216, v216, v232
  v_mul_f32 v217, v217, v232
  v_mul_f32_e64 v218, v218, v232
  v_cvt_pk_bf16_f32 v100, v212, v213
  v_cvt_pk_bf16_f32 v101, v214, v215
  v_cvt_pk_bf16_f32 v102, v216, v217
  v_cvt_pk_bf16_f32 v103, v218, 0
  v_mfma_f32_16x16x32_bf16 v[16:19], v[140:143], v[96:99], 0
  v_mfma_f32_16x16x32_bf16 v[32:35], v[144:147], v[96:99], 0
  v_mfma_f32_16x16x32_bf16 v[48:51], v[148:151], v[96:99], 0
  v_mfma_f32_16x16x32_bf16 v[64:67], v[152:155], v[96:99], 0
  v_mul_f32 v220, v220, v234
  v_mul_f32 v221, v221, v234
  v_mul_f32 v222, v222, v234
  v_mul_f32 v223, v223, v234
  v_mul_f32 v224, v224, v234
  v_mul_f32 v225, v225, v234
  v_mul_f32_e64 v226, v226, v234
  v_cvt_pk_bf16_f32 v104, v220, v221
  v_cvt_pk_bf16_f32 v105, v222, v223
  v_cvt_pk_bf16_f32 v106, v224, v225
  v_cvt_pk_bf16_f32 v107, v226, 0
  v_mfma_f32_16x16x32_bf16 v[20:23], v[140:143], v[100:103], 0
  v_mfma_f32_16x16x32_bf16 v[36:39], v[144:147], v[100:103], 0
  v_mfma_f32_16x16x32_bf16 v[52:55], v[148:151], v[100:103], 0
  v_mfma_f32_16x16x32_bf16 v[68:71], v[152:155], v[100:103], 0
  v_mfma_f32_16x16x32_bf16 v[24:27], v[140:143], v[104:107], 0
  v_mfma_f32_16x16x32_bf16 v[40:43], v[144:147], v[104:107], 0
  v_mfma_f32_16x16x32_bf16 v[56:59], v[148:151], v[104:107], 0
  v_mfma_f32_16x16x32_bf16 v[72:75], v[152:155], v[104:107], 0
  s_waitcnt vmcnt(20)
  s_nop 0
  ds_read2st64_b32 v[76:77], v6 offset0:16 offset1:17
  ds_read2st64_b32 v[78:79], v6 offset0:18 offset1:19
  ds_read2st64_b32 v[80:81], v6 offset0:20 offset1:21
  ds_read2st64_b32 v[82:83], v6 offset0:22 offset1:23
  ds_read2st64_b32 v[84:85], v7 offset0:24 offset1:25
  ds_read2st64_b32 v[86:87], v7 offset0:26 offset1:27
  ds_read2st64_b32 v[88:89], v7 offset0:28 offset1:29
  ds_read2st64_b32 v[90:91], v7 offset0:30 offset1:31
  s_waitcnt lgkmcnt(0)
  s_nop 0
  v_cvt_pk_bf16_f32 v188, v76, v77
  v_cvt_pk_bf16_f32 v189, v78, v79
  v_cvt_pk_bf16_f32 v190, v80, v81
  v_cvt_pk_bf16_f32 v191, v82, v83
  v_cvt_pk_bf16_f32 v192, v84, v85
  v_cvt_pk_bf16_f32 v193, v86, v87
  v_cvt_pk_bf16_f32 v194, v88, v89
  v_cvt_pk_bf16_f32 v195, v90, v91
  s_add_u32 m0, s30, 4096
  s_nop 0
  s_nop 0
  buffer_load_dwordx4 v8, s[12:15], s29 offen offset:0 lds
  buffer_load_dwordx4 v8, s[12:15], s29 offen offset:1024 lds
  buffer_load_dwordx4 v8, s[12:15], s29 offen offset:2048 lds
  buffer_load_dwordx4 v8, s[12:15], s29 offen offset:3072 lds
  s_add_u32 s29, s29, 4096
  buffer_load_dwordx4 v[92:95], v8, s[12:15], s24 offen offset:3072
  buffer_load_dwordx4 v[96:99], v8, s[12:15], s25 offen offset:3072
  buffer_load_dwordx4 v[100:103], v8, s[12:15], s26 offen offset:3072
  buffer_load_dwordx4 v[104:107], v8, s[12:15], s27 offen offset:3072
  s_waitcnt vmcnt(24)
  v_and_b32 v110, v9, v110
  v_and_b32 v111, v9, v111
  v_and_b32 v114, v9, v114
  v_and_b32 v115, v9, v115
  v_and_b32 v118, v9, v118
  v_and_b32 v119, v9, v119
  v_and_b32 v122, v9, v122
  v_and_b32_e64 v123, v9, v123
  v_mfma_f32_16x16x32_bf16 v[200:203], v[192:195], v[108:111], 0
  v_mfma_f32_16x16x32_bf16 v[196:199], v[188:191], v[108:111], 0
  v_mfma_f32_16x16x32_bf16 v[208:211], v[192:195], v[112:115], 0
  v_mfma_f32_16x16x32_bf16 v[204:207], v[188:191], v[112:115], 0
  v_mfma_f32_16x16x32_bf16 v[216:219], v[192:195], v[116:119], 0
  v_mfma_f32_16x16x32_bf16 v[212:215], v[188:191], v[116:119], 0
  v_mfma_f32_16x16x32_bf16 v[224:227], v[192:195], v[120:123], 0
  v_mfma_f32_16x16x32_bf16 v[220:223], v[188:191], v[120:123], 0
  buffer_load_dwordx4 v[140:143], v8, s[12:15], s28 offen offset:0
  buffer_load_dwordx4 v[144:147], v8, s[12:15], s28 offen offset:1024
  buffer_load_dwordx4 v[148:151], v8, s[12:15], s28 offen offset:2048
  buffer_load_dwordx4 v[152:155], v8, s[12:15], s28 offen offset:3072
  s_add_u32 s28, s28, 4096
  v_add_f32 v228, 0x358637bd, v203
  v_add_f32 v230, 0x358637bd, v211
  v_add_f32 v232, 0x358637bd, v219
  v_add_f32 v234, 0x358637bd, v227
  v_rcp_f32 v228, v228
  v_rcp_f32 v230, v230
  v_rcp_f32 v232, v232
  v_rcp_f32 v234, v234
  s_waitcnt vmcnt(24)
  v_mul_f32 v196, v196, v228
  v_mul_f32 v197, v197, v228
  v_mul_f32 v198, v198, v228
  v_mul_f32 v199, v199, v228
  v_mul_f32 v200, v200, v228
  v_mul_f32 v201, v201, v228
  v_mul_f32 v202, v202, v228
  v_cvt_pk_bf16_f32 v108, v196, v197
  v_cvt_pk_bf16_f32 v109, v198, v199
  v_cvt_pk_bf16_f32 v110, v200, v201
  v_cvt_pk_bf16_f32 v111, v202, 0
  v_mul_f32 v204, v204, v230
  v_mul_f32 v205, v205, v230
  v_mul_f32 v206, v206, v230
  v_mul_f32 v207, v207, v230
  v_mul_f32 v208, v208, v230
  v_mul_f32 v209, v209, v230
  v_mul_f32_e64 v210, v210, v230
  v_cvt_pk_bf16_f32 v112, v204, v205
  v_cvt_pk_bf16_f32 v113, v206, v207
  v_cvt_pk_bf16_f32 v114, v208, v209
  v_cvt_pk_bf16_f32 v115, v210, 0
  v_mfma_f32_16x16x32_bf16 v[12:15], v[156:159], v[108:111], v[12:15]
  v_mfma_f32_16x16x32_bf16 v[28:31], v[160:163], v[108:111], v[28:31]
  v_mfma_f32_16x16x32_bf16 v[44:47], v[164:167], v[108:111], v[44:47]
  v_mfma_f32_16x16x32_bf16 v[60:63], v[168:171], v[108:111], v[60:63]
  v_mul_f32 v212, v212, v232
  v_mul_f32 v213, v213, v232
  v_mul_f32 v214, v214, v232
  v_mul_f32 v215, v215, v232
  v_mul_f32 v216, v216, v232
  v_mul_f32 v217, v217, v232
  v_mul_f32_e64 v218, v218, v232
  v_cvt_pk_bf16_f32 v116, v212, v213
  v_cvt_pk_bf16_f32 v117, v214, v215
  v_cvt_pk_bf16_f32 v118, v216, v217
  v_cvt_pk_bf16_f32 v119, v218, 0
  v_mfma_f32_16x16x32_bf16 v[16:19], v[156:159], v[112:115], v[16:19]
  v_mfma_f32_16x16x32_bf16 v[32:35], v[160:163], v[112:115], v[32:35]
  v_mfma_f32_16x16x32_bf16 v[48:51], v[164:167], v[112:115], v[48:51]
  v_mfma_f32_16x16x32_bf16 v[64:67], v[168:171], v[112:115], v[64:67]
  v_mul_f32 v220, v220, v234
  v_mul_f32 v221, v221, v234
  v_mul_f32 v222, v222, v234
  v_mul_f32 v223, v223, v234
  v_mul_f32 v224, v224, v234
  v_mul_f32 v225, v225, v234
  v_mul_f32_e64 v226, v226, v234
  v_cvt_pk_bf16_f32 v120, v220, v221
  v_cvt_pk_bf16_f32 v121, v222, v223
  v_cvt_pk_bf16_f32 v122, v224, v225
  v_cvt_pk_bf16_f32 v123, v226, 0
  v_mfma_f32_16x16x32_bf16 v[20:23], v[156:159], v[116:119], v[20:23]
  v_mfma_f32_16x16x32_bf16 v[36:39], v[160:163], v[116:119], v[36:39]
  v_mfma_f32_16x16x32_bf16 v[52:55], v[164:167], v[116:119], v[52:55]
  v_mfma_f32_16x16x32_bf16 v[68:71], v[168:171], v[116:119], v[68:71]
  v_mfma_f32_16x16x32_bf16 v[24:27], v[156:159], v[120:123], v[24:27]
  v_mfma_f32_16x16x32_bf16 v[40:43], v[160:163], v[120:123], v[40:43]
  v_mfma_f32_16x16x32_bf16 v[56:59], v[164:167], v[120:123], v[56:59]
  v_mfma_f32_16x16x32_bf16 v[72:75], v[168:171], v[120:123], v[72:75]
  s_waitcnt vmcnt(20)
  s_nop 0
  ds_read2st64_b32 v[76:77], v6 offset0:0 offset1:1
  ds_read2st64_b32 v[78:79], v6 offset0:2 offset1:3
  ds_read2st64_b32 v[80:81], v6 offset0:4 offset1:5
  ds_read2st64_b32 v[82:83], v6 offset0:6 offset1:7
  ds_read2st64_b32 v[84:85], v7 offset0:8 offset1:9
  ds_read2st64_b32 v[86:87], v7 offset0:10 offset1:11
  ds_read2st64_b32 v[88:89], v7 offset0:12 offset1:13
  ds_read2st64_b32 v[90:91], v7 offset0:14 offset1:15
  s_waitcnt lgkmcnt(0)
  s_nop 0
  v_cvt_pk_bf16_f32 v188, v76, v77
  v_cvt_pk_bf16_f32 v189, v78, v79
  v_cvt_pk_bf16_f32 v190, v80, v81
  v_cvt_pk_bf16_f32 v191, v82, v83
  v_cvt_pk_bf16_f32 v192, v84, v85
  v_cvt_pk_bf16_f32 v193, v86, v87
  v_cvt_pk_bf16_f32 v194, v88, v89
  v_cvt_pk_bf16_f32 v195, v90, v91
  s_waitcnt vmcnt(16)
  v_and_b32 v126, v9, v126
  v_and_b32 v127, v9, v127
  v_and_b32 v130, v9, v130
  v_and_b32 v131, v9, v131
  v_and_b32 v134, v9, v134
  v_and_b32 v135, v9, v135
  v_and_b32 v138, v9, v138
  v_and_b32_e64 v139, v9, v139
  v_mfma_f32_16x16x32_bf16 v[200:203], v[192:195], v[124:127], 0
  v_mfma_f32_16x16x32_bf16 v[196:199], v[188:191], v[124:127], 0
  v_mfma_f32_16x16x32_bf16 v[208:211], v[192:195], v[128:131], 0
  v_mfma_f32_16x16x32_bf16 v[204:207], v[188:191], v[128:131], 0
  v_mfma_f32_16x16x32_bf16 v[216:219], v[192:195], v[132:135], 0
  v_mfma_f32_16x16x32_bf16 v[212:215], v[188:191], v[132:135], 0
  v_mfma_f32_16x16x32_bf16 v[224:227], v[192:195], v[136:139], 0
  v_mfma_f32_16x16x32_bf16 v[220:223], v[188:191], v[136:139], 0
  s_nop 0
  v_add_f32 v228, 0x358637bd, v203
  s_nop 0
  v_add_f32 v230, 0x358637bd, v211
  s_nop 0
  v_add_f32 v232, 0x358637bd, v219
  s_nop 0
  v_add_f32 v234, 0x358637bd, v227
  v_rcp_f32 v228, v228
  v_rcp_f32 v230, v230
  v_rcp_f32 v232, v232
  v_rcp_f32 v234, v234
  s_waitcnt vmcnt(12)
  v_mul_f32 v196, v196, v228
  v_mul_f32 v197, v197, v228
  v_mul_f32 v198, v198, v228
  v_mul_f32 v199, v199, v228
  v_mul_f32 v200, v200, v228
  v_mul_f32 v201, v201, v228
  v_mul_f32 v202, v202, v228
  v_cvt_pk_bf16_f32 v124, v196, v197
  v_cvt_pk_bf16_f32 v125, v198, v199
  v_cvt_pk_bf16_f32 v126, v200, v201
  v_cvt_pk_bf16_f32 v127, v202, 0
  v_mul_f32 v204, v204, v230
  v_mul_f32 v205, v205, v230
  v_mul_f32 v206, v206, v230
  v_mul_f32 v207, v207, v230
  v_mul_f32 v208, v208, v230
  v_mul_f32 v209, v209, v230
  v_mul_f32_e64 v210, v210, v230
  v_cvt_pk_bf16_f32 v128, v204, v205
  v_cvt_pk_bf16_f32 v129, v206, v207
  v_cvt_pk_bf16_f32 v130, v208, v209
  v_cvt_pk_bf16_f32 v131, v210, 0
  v_mfma_f32_16x16x32_bf16 v[12:15], v[172:175], v[124:127], v[12:15]
  v_mfma_f32_16x16x32_bf16 v[28:31], v[176:179], v[124:127], v[28:31]
  v_mfma_f32_16x16x32_bf16 v[44:47], v[180:183], v[124:127], v[44:47]
  v_mfma_f32_16x16x32_bf16 v[60:63], v[184:187], v[124:127], v[60:63]
  v_mul_f32 v212, v212, v232
  v_mul_f32 v213, v213, v232
  v_mul_f32 v214, v214, v232
  v_mul_f32 v215, v215, v232
  v_mul_f32 v216, v216, v232
  v_mul_f32 v217, v217, v232
  v_mul_f32_e64 v218, v218, v232
  v_cvt_pk_bf16_f32 v132, v212, v213
  v_cvt_pk_bf16_f32 v133, v214, v215
  v_cvt_pk_bf16_f32 v134, v216, v217
  v_cvt_pk_bf16_f32 v135, v218, 0
  v_mfma_f32_16x16x32_bf16 v[16:19], v[172:175], v[128:131], v[16:19]
  v_mfma_f32_16x16x32_bf16 v[32:35], v[176:179], v[128:131], v[32:35]
  v_mfma_f32_16x16x32_bf16 v[48:51], v[180:183], v[128:131], v[48:51]
  v_mfma_f32_16x16x32_bf16 v[64:67], v[184:187], v[128:131], v[64:67]
  v_mul_f32 v220, v220, v234
  v_mul_f32 v221, v221, v234
  v_mul_f32 v222, v222, v234
  v_mul_f32 v223, v223, v234
  v_mul_f32 v224, v224, v234
  v_mul_f32 v225, v225, v234
  v_mul_f32_e64 v226, v226, v234
  v_cvt_pk_bf16_f32 v136, v220, v221
  v_cvt_pk_bf16_f32 v137, v222, v223
  v_cvt_pk_bf16_f32 v138, v224, v225
  v_cvt_pk_bf16_f32 v139, v226, 0
  v_mfma_f32_16x16x32_bf16 v[20:23], v[172:175], v[132:135], v[20:23]
  v_mfma_f32_16x16x32_bf16 v[36:39], v[176:179], v[132:135], v[36:39]
  v_mfma_f32_16x16x32_bf16 v[52:55], v[180:183], v[132:135], v[52:55]
  v_mfma_f32_16x16x32_bf16 v[68:71], v[184:187], v[132:135], v[68:71]
  v_mfma_f32_16x16x32_bf16 v[24:27], v[172:175], v[136:139], v[24:27]
  v_mfma_f32_16x16x32_bf16 v[40:43], v[176:179], v[136:139], v[40:43]
  v_mfma_f32_16x16x32_bf16 v[56:59], v[180:183], v[136:139], v[56:59]
  v_mfma_f32_16x16x32_bf16 v[72:75], v[184:187], v[136:139], v[72:75]
  s_waitcnt vmcnt(8)
  s_nop 0
  ds_read2st64_b32 v[76:77], v6 offset0:16 offset1:17
  ds_read2st64_b32 v[78:79], v6 offset0:18 offset1:19
  ds_read2st64_b32 v[80:81], v6 offset0:20 offset1:21
  ds_read2st64_b32 v[82:83], v6 offset0:22 offset1:23
  ds_read2st64_b32 v[84:85], v7 offset0:24 offset1:25
  ds_read2st64_b32 v[86:87], v7 offset0:26 offset1:27
  ds_read2st64_b32 v[88:89], v7 offset0:28 offset1:29
  ds_read2st64_b32 v[90:91], v7 offset0:30 offset1:31
  s_waitcnt lgkmcnt(0)
  s_nop 0
  v_cvt_pk_bf16_f32 v188, v76, v77
  v_cvt_pk_bf16_f32 v189, v78, v79
  v_cvt_pk_bf16_f32 v190, v80, v81
  v_cvt_pk_bf16_f32 v191, v82, v83
  v_cvt_pk_bf16_f32 v192, v84, v85
  v_cvt_pk_bf16_f32 v193, v86, v87
  v_cvt_pk_bf16_f32 v194, v88, v89
  v_cvt_pk_bf16_f32 v195, v90, v91
  s_waitcnt vmcnt(4)
  v_and_b32 v94, v9, v94
  v_and_b32 v95, v9, v95
  v_and_b32 v98, v9, v98
  v_and_b32 v99, v9, v99
  v_and_b32 v102, v9, v102
  v_and_b32 v103, v9, v103
  v_and_b32 v106, v9, v106
  v_and_b32_e64 v107, v9, v107
  v_mfma_f32_16x16x32_bf16 v[200:203], v[192:195], v[92:95], 0
  v_mfma_f32_16x16x32_bf16 v[196:199], v[188:191], v[92:95], 0
  v_mfma_f32_16x16x32_bf16 v[208:211], v[192:195], v[96:99], 0
  v_mfma_f32_16x16x32_bf16 v[204:207], v[188:191], v[96:99], 0
  v_mfma_f32_16x16x32_bf16 v[216:219], v[192:195], v[100:103], 0
  v_mfma_f32_16x16x32_bf16 v[212:215], v[188:191], v[100:103], 0
  v_mfma_f32_16x16x32_bf16 v[224:227], v[192:195], v[104:107], 0
  v_mfma_f32_16x16x32_bf16 v[220:223], v[188:191], v[104:107], 0
  s_nop 0
  v_add_f32 v228, 0x358637bd, v203
  s_nop 0
  v_add_f32 v230, 0x358637bd, v211
  s_nop 0
  v_add_f32 v232, 0x358637bd, v219
  s_nop 0
  v_add_f32 v234, 0x358637bd, v227
  v_rcp_f32 v228, v228
  v_rcp_f32 v230, v230
  v_rcp_f32 v232, v232
  v_rcp_f32 v234, v234
  s_waitcnt vmcnt(0)
  v_mul_f32 v196, v196, v228
  v_mul_f32 v197, v197, v228
  v_mul_f32 v198, v198, v228
  v_mul_f32 v199, v199, v228
  v_mul_f32 v200, v200, v228
  v_mul_f32 v201, v201, v228
  v_mul_f32 v202, v202, v228
  v_cvt_pk_bf16_f32 v92, v196, v197
  v_cvt_pk_bf16_f32 v93, v198, v199
  v_cvt_pk_bf16_f32 v94, v200, v201
  v_cvt_pk_bf16_f32 v95, v202, 0
  v_mul_f32 v204, v204, v230
  v_mul_f32 v205, v205, v230
  v_mul_f32 v206, v206, v230
  v_mul_f32 v207, v207, v230
  v_mul_f32 v208, v208, v230
  v_mul_f32 v209, v209, v230
  v_mul_f32_e64 v210, v210, v230
  v_cvt_pk_bf16_f32 v96, v204, v205
  v_cvt_pk_bf16_f32 v97, v206, v207
  v_cvt_pk_bf16_f32 v98, v208, v209
  v_cvt_pk_bf16_f32 v99, v210, 0
  v_mfma_f32_16x16x32_bf16 v[12:15], v[140:143], v[92:95], v[12:15]
  v_mfma_f32_16x16x32_bf16 v[28:31], v[144:147], v[92:95], v[28:31]
  v_mfma_f32_16x16x32_bf16 v[44:47], v[148:151], v[92:95], v[44:47]
  v_mfma_f32_16x16x32_bf16 v[60:63], v[152:155], v[92:95], v[60:63]
  v_mul_f32 v212, v212, v232
  v_mul_f32 v213, v213, v232
  v_mul_f32 v214, v214, v232
  v_mul_f32 v215, v215, v232
  v_mul_f32 v216, v216, v232
  v_mul_f32 v217, v217, v232
  v_mul_f32_e64 v218, v218, v232
  v_cvt_pk_bf16_f32 v100, v212, v213
  v_cvt_pk_bf16_f32 v101, v214, v215
  v_cvt_pk_bf16_f32 v102, v216, v217
  v_cvt_pk_bf16_f32 v103, v218, 0
  v_mfma_f32_16x16x32_bf16 v[16:19], v[140:143], v[96:99], v[16:19]
  v_mfma_f32_16x16x32_bf16 v[32:35], v[144:147], v[96:99], v[32:35]
  v_mfma_f32_16x16x32_bf16 v[48:51], v[148:151], v[96:99], v[48:51]
  v_mfma_f32_16x16x32_bf16 v[64:67], v[152:155], v[96:99], v[64:67]
  v_mul_f32 v220, v220, v234
  v_mul_f32 v221, v221, v234
  v_mul_f32 v222, v222, v234
  v_mul_f32 v223, v223, v234
  v_mul_f32 v224, v224, v234
  v_mul_f32 v225, v225, v234
  v_mul_f32_e64 v226, v226, v234
  v_cvt_pk_bf16_f32 v104, v220, v221
  v_cvt_pk_bf16_f32 v105, v222, v223
  v_cvt_pk_bf16_f32 v106, v224, v225
  v_cvt_pk_bf16_f32 v107, v226, 0
  v_mfma_f32_16x16x32_bf16 v[20:23], v[140:143], v[100:103], v[20:23]
  v_mfma_f32_16x16x32_bf16 v[36:39], v[144:147], v[100:103], v[36:39]
  v_mfma_f32_16x16x32_bf16 v[52:55], v[148:151], v[100:103], v[52:55]
  v_mfma_f32_16x16x32_bf16 v[68:71], v[152:155], v[100:103], v[68:71]
  v_mfma_f32_16x16x32_bf16 v[24:27], v[140:143], v[104:107], v[24:27]
  v_mfma_f32_16x16x32_bf16 v[40:43], v[144:147], v[104:107], v[40:43]
  v_mfma_f32_16x16x32_bf16 v[56:59], v[148:151], v[104:107], v[56:59]
  v_mfma_f32_16x16x32_bf16 v[72:75], v[152:155], v[104:107], v[72:75]
  s_add_u32 s60, s22, 1
  s_and_b32 s60, s60, 3
  s_mul_i32 s60, s60, 12288
  s_add_u32 s60, s60, 70656
  v_add_u32_e64 v4, s60, v8
  ds_write_b128 v4, v[16:19] offset:0
  ds_write_b128 v4, v[32:35] offset:1024
  ds_write_b128 v4, v[48:51] offset:2048
  ds_write_b128 v4, v[64:67] offset:3072
  s_add_u32 s60, s22, 2
  s_and_b32 s60, s60, 3
  s_mul_i32 s60, s60, 12288
  s_add_u32 s60, s60, 74752
  v_add_u32_e64 v4, s60, v8
  ds_write_b128 v4, v[20:23] offset:0
  ds_write_b128 v4, v[36:39] offset:1024
  ds_write_b128 v4, v[52:55] offset:2048
  ds_write_b128 v4, v[68:71] offset:3072
  s_add_u32 s60, s22, 3
  s_and_b32 s60, s60, 3
  s_mul_i32 s60, s60, 12288
  s_add_u32 s60, s60, 78848
  v_add_u32_e64 v4, s60, v8
  ds_write_b128 v4, v[24:27] offset:0
  ds_write_b128 v4, v[40:43] offset:1024
  ds_write_b128 v4, v[56:59] offset:2048
  ds_write_b128 v4, v[72:75] offset:3072
  v_mul_u32_u24 v5, 1792, v2
  v_lshl_add_u32 v5, v3, 4, v5
  s_lshl_b32 s60, s21, 2
  s_add_u32 s60, s60, s22
  s_mul_i32 s60, s60, 28672
  s_lshl_b32 s61, s23, 7
  s_add_u32 s60, s60, s61
  s_waitcnt lgkmcnt(0)
  v_mov_b32 v4, 1
  s_mov_b64 s[68:69], exec
  s_mov_b64 exec, 1
  ds_add_u32 v1, v4 offset:4
  s_mov_b64 exec, s[68:69]
  s_mov_b32 s69, 0
L2_a2sync:
  ds_read_b32 v4, v1 offset:4
  s_add_u32 s69, s69, 1
  s_cmp_gt_u32 s69, 0x100000
  s_cbranch_scc1 L2_a2sync_x
  s_waitcnt lgkmcnt(0)
  v_readfirstlane_b32 s68, v4
  s_cmp_lt_u32 s68, 4
  s_cbranch_scc1 L2_a2sync
L2_a2sync_x:
  s_mul_i32 s61, s22, 12288
  s_add_u32 s61, s61, 70656
  v_add_u32_e64 v4, s61, v8
  ds_read_b128 v[16:19], v4 offset:0
  ds_read_b128 v[20:23], v4 offset:4096
  ds_read_b128 v[24:27], v4 offset:8192
  ds_read_b128 v[32:35], v4 offset:1024
  ds_read_b128 v[36:39], v4 offset:5120
  ds_read_b128 v[40:43], v4 offset:9216
  ds_read_b128 v[48:51], v4 offset:2048
  ds_read_b128 v[52:55], v4 offset:6144
  ds_read_b128 v[56:59], v4 offset:10240
  ds_read_b128 v[64:67], v4 offset:3072
  ds_read_b128 v[68:71], v4 offset:7168
  ds_read_b128 v[72:75], v4 offset:11264
  s_waitcnt lgkmcnt(9)
  s_nop 0
  v_pk_add_f32 v[12:13], v[12:13], v[16:17]
  v_pk_add_f32 v[20:21], v[20:21], v[24:25]
  v_pk_add_f32 v[14:15], v[14:15], v[18:19]
  v_pk_add_f32 v[22:23], v[22:23], v[26:27]
  v_pk_add_f32 v[12:13], v[12:13], v[20:21]
  v_pk_add_f32 v[14:15], v[14:15], v[22:23]
  v_cvt_pk_bf16_f32 v140, v12, v13
  v_cvt_pk_bf16_f32 v141, v14, v15
  s_waitcnt lgkmcnt(6)
  s_nop 0
  v_pk_add_f32 v[28:29], v[28:29], v[32:33]
  v_pk_add_f32 v[36:37], v[36:37], v[40:41]
  v_pk_add_f32 v[30:31], v[30:31], v[34:35]
  v_pk_add_f32 v[38:39], v[38:39], v[42:43]
  v_pk_add_f32 v[28:29], v[28:29], v[36:37]
  v_pk_add_f32 v[30:31], v[30:31], v[38:39]
  v_cvt_pk_bf16_f32 v142, v28, v29
  v_cvt_pk_bf16_f32 v143, v30, v31
  buffer_store_dwordx4 v[140:143], v5, s[16:19], s60 offen offset:0
  s_waitcnt lgkmcnt(3)
  s_nop 0
  v_pk_add_f32 v[44:45], v[44:45], v[48:49]
  v_pk_add_f32 v[52:53], v[52:53], v[56:57]
  v_pk_add_f32 v[46:47], v[46:47], v[50:51]
  v_pk_add_f32 v[54:55], v[54:55], v[58:59]
  v_pk_add_f32 v[44:45], v[44:45], v[52:53]
  v_pk_add_f32 v[46:47], v[46:47], v[54:55]
  v_cvt_pk_bf16_f32 v144, v44, v45
  v_cvt_pk_bf16_f32 v145, v46, v47
  s_waitcnt lgkmcnt(0)
  s_nop 0
  v_pk_add_f32 v[60:61], v[60:61], v[64:65]
  v_pk_add_f32 v[68:69], v[68:69], v[72:73]
  v_pk_add_f32 v[62:63], v[62:63], v[66:67]
  v_pk_add_f32 v[70:71], v[70:71], v[74:75]
  v_pk_add_f32 v[60:61], v[60:61], v[68:69]
  v_pk_add_f32 v[62:63], v[62:63], v[70:71]
  v_cvt_pk_bf16_f32 v146, v60, v61
  v_cvt_pk_bf16_f32 v147, v62, v63
  buffer_store_dwordx4 v[144:147], v5, s[16:19], s60 offen offset:64
  s_endpgm
L2_end:
  s_endpgm
.section .rodata,"a"
.p2align 6
.amdhsa_kernel p1_kernel
  .amdhsa_next_free_vgpr 128
  .amdhsa_next_free_sgpr 102
  .amdhsa_accum_offset 128
  .amdhsa_group_segment_fixed_size 0
  .amdhsa_kernarg_size 104
  .amdhsa_user_sgpr_count 2
  .amdhsa_user_sgpr_kernarg_segment_ptr 1
  .amdhsa_system_sgpr_workgroup_id_x 1
.end_amdhsa_kernel
.section .rodata,"a"
.p2align 6
.amdhsa_kernel p2_kernel
  .amdhsa_next_free_vgpr 256
  .amdhsa_next_free_sgpr 102
  .amdhsa_accum_offset 256
  .amdhsa_group_segment_fixed_size 0
  .amdhsa_kernarg_size 104
  .amdhsa_user_sgpr_count 2
  .amdhsa_user_sgpr_kernarg_segment_ptr 1
  .amdhsa_system_sgpr_workgroup_id_x 1
.end_amdhsa_kernel
```
